```python
import torch

def _softmax(x, axis=-1):
    return torch.softmax(x, dim=axis)
def _gelu(x):
    return torch.nn.functional.gelu(x, approximate="tanh")
def _silu(x):
    return torch.nn.functional.silu(x)
def _sigmoid(x):
    return torch.sigmoid(x)
def _layernorm(x, axis=-1, eps=1e-5):
    m = x.mean(dim=axis, keepdim=True)
    v = x.var(dim=axis, keepdim=True, unbiased=False)
    return (x - m) / torch.sqrt(v + eps)
def _scatter_add(tgt, idx, src, axis=0):
    return tgt.clone().index_add_(axis, idx, src)
def _segment_sum(src, seg, n):
    out = torch.zeros((n,) + src.shape[1:], dtype=src.dtype)
    return out.index_add_(0, seg, src)
def _pad(x, pw):
    flat = tuple(v for pair in reversed(pw) for v in pair)
    return torch.nn.functional.pad(x, flat)

kernel_name = 'sequential_preLN__grouped_kv_mqa__mixer_s_mlp__prompt'

def setup_inputs():

    _w = (lambda a: (lambda t: t.to(torch.bfloat16) if t.is_floating_point() else t)(torch.as_tensor(a)))
    def _A_setup():
        B, S, D, H = 1, 2048, 640, 32
        Dh = D // H
        return {
            "x": _w((lambda *s: torch.randn(*s, dtype=torch.bfloat16) * 0.05)(B, S, D)),
            "wq": _w((lambda *s: torch.randn(*s, dtype=torch.bfloat16) * 0.05)(D, H * Dh)),
            "wk": _w((lambda *s: torch.randn(*s, dtype=torch.bfloat16) * 0.05)(D, Dh)),
            "wv": _w((lambda *s: torch.randn(*s, dtype=torch.bfloat16) * 0.05)(D, Dh)),
            "wo": _w((lambda *s: torch.randn(*s, dtype=torch.bfloat16) * 0.05)(H * Dh, D)),
        }
    _A_in = _A_setup()

    def _B_setup():
        B, S, D, F = 1, 2048, 640, 1728
        return {
            "x":  _w((lambda *s: torch.randn(*s, dtype=torch.bfloat16) * 0.05)(B, S, D)),
            "w1": _w((lambda *s: torch.randn(*s, dtype=torch.bfloat16) * 3.2)(D, D) * (D ** -0.5)),
            "w2": _w((lambda *s: torch.randn(*s, dtype=torch.bfloat16) * 3.2)(D, D) * (D ** -0.5)),
            "w3": _w((lambda *s: torch.randn(*s, dtype=torch.bfloat16) * 3.2)(D, F) * (D ** -0.5)),
            "w4": _w((lambda *s: torch.randn(*s, dtype=torch.bfloat16) * 3.2)(F, D) * (F ** -0.5)),
        }
    _B_in = _B_setup()

    return {
        "A_x": _A_in["x"],
        "A_wq": _A_in["wq"],
        "A_wk": _A_in["wk"],
        "A_wv": _A_in["wv"],
        "A_wo": _A_in["wo"],
        "B_x": _B_in["x"],
        "B_w1": _B_in["w1"],
        "B_w2": _B_in["w2"],
        "B_w3": _B_in["w3"],
        "B_w4": _B_in["w4"],
    }

def reference(A_x, A_wq, A_wk, A_wv, A_wo, B_x, B_w1, B_w2, B_w3, B_w4):
    def _A_ref(x, wq, wk, wv, wo):
        B, S, D = x.shape
        H = 32
        Dh = D // H
        q = (lambda x, *d: x.permute(*d))((x @ wq).reshape(B, S, H, Dh), 0, 2, 1, 3)
        k = x @ wk
        v = x @ wv
        scores = torch.einsum("bhqd,bkd->bhqk", q, k) * (Dh ** -0.5)
        p = _softmax(scores, axis=-1)
        o = torch.einsum("bhqk,bkd->bhqd", p, v)
        return (lambda x, *d: x.permute(*d))(o, 0, 2, 1, 3).reshape(B, S, H * Dh) @ wo

    def _B_ref(x, w1, w2, w3, w4):
        B, S, D = x.shape
        h = _gelu(_layernorm(x, axis=-1) @ w1)
        c = D // 4
        g0 = _pad(h[:, :, 0*c:1*c], ((0, 0), (1, 0), (0, 0)))[:, :S, :]
        g1 = _pad(h[:, :, 1*c:2*c], ((0, 0), (0, 1), (0, 0)))[:, 1:, :]
        g2 = _pad(h[:, :, 2*c:3*c], ((0, 0), (2, 0), (0, 0)))[:, :S, :]
        g3 = _pad(h[:, :, 3*c:   ], ((0, 0), (0, 2), (0, 0)))[:, 2:, :]
        hs = torch.concatenate([g0, g1, g2, g3], axis=-1) @ w2
        x1 = x + hs
        h2 = _gelu(_layernorm(x1, axis=-1) @ w3) @ w4
        return x1 + h2

    x = A_x
    h = x + _A_ref(_layernorm(x, axis=-1), A_wq, A_wk, A_wv, A_wo)
    h2 = h + _B_ref(_layernorm(h, axis=-1), B_w1, B_w2, B_w3, B_w4)
    return h2
```

```asm
; @launch kernel=k1_qkv_kernel grid=(288,1,1) block=(256,1,1) lds=81920
; @launch kernel=k2_attn_kernel grid=(256,1,1) block=(1024,1,1) lds=131072
; @launch kernel=k3_wo_kernel grid=(256,1,1) block=(256,1,1) lds=122880
; @launch kernel=k4_w1_kernel grid=(256,1,1) block=(256,1,1) lds=122880
; @launch kernel=k5_w2_kernel grid=(256,1,1) block=(256,1,1) lds=122880
; @launch kernel=k6_w3_kernel grid=(256,1,1) block=(256,1,1) lds=147456
; @launch kernel=k7_w4_kernel grid=(256,1,1) block=(256,1,1) lds=122880
.amdgcn_target "amdgcn-amd-amdhsa--gfx950"
.text
.globl k1_qkv_kernel
.p2align 8
.type k1_qkv_kernel,@function
k1_qkv_kernel:
    s_cmp_ge_u32 s2, 288
    s_cbranch_scc1 k1_qkv_kernel_end
    s_load_dwordx2 s[4:5], s[0:1], 96
    s_load_dwordx2 s[6:7], s[0:1], 8
    s_load_dwordx2 s[34:35], s[0:1], 0
    s_load_dwordx2 s[36:37], s[0:1], 16
    s_load_dwordx2 s[38:39], s[0:1], 24
    s_mul_hi_u32 s32, s2, 477218589
    s_mul_i32 s33, s32, 9
    s_sub_u32 s33, s2, s33
    s_lshl_b32 s40, s32, 6
    s_mul_i32 s41, s33, 80
    v_lshrrev_b32 v1, 6, v0
    v_and_b32 v2, 63, v0
    v_readfirstlane_b32 s42, v1
    v_lshrrev_b32 v8, 3, v2
    v_and_b32 v9, 7, v2
    v_xor_b32 v9, v9, v8
    s_lshl_b32 s43, s42, 4
    s_add_u32 s43, s43, s40
    v_add_u32 v10, s43, v8
    s_mov_b32 s45, 1280
    v_mul_lo_u32 v10, v10, s45
    v_lshl_add_u32 v10, v9, 4, v10
    v_add_u32 v11, 10240, v10
    s_mov_b32 s46, 1280
    s_mov_b32 s48, 429496730
    s_lshl_b32 s47, s41, 1
    s_mul_i32 s44, s42, 192
    v_add_u32 v50, s44, v2
    v_mul_hi_u32 v51, v50, s48
    v_mul_u32_u24 v52, 10, v51
    v_sub_u32 v52, v50, v52
    v_mul_lo_u32 v53, v51, s46
    v_lshl_add_u32 v53, v52, 4, v53
    v_add_u32 v240, s47, v53
    v_mov_b32 v53, 0x7ffffff0
    v_cmp_le_u32 vcc, 640, v50
    s_nop 1
    v_cndmask_b32 v240, v240, v53, vcc
    v_add_u32 v50, s44, v2
    v_add_u32 v50, 64, v50
    v_mul_hi_u32 v51, v50, s48
    v_mul_u32_u24 v52, 10, v51
    v_sub_u32 v52, v50, v52
    v_mul_lo_u32 v53, v51, s46
    v_lshl_add_u32 v53, v52, 4, v53
    v_add_u32 v241, s47, v53
    v_mov_b32 v53, 0x7ffffff0
    v_cmp_le_u32 vcc, 640, v50
    s_nop 1
    v_cndmask_b32 v241, v241, v53, vcc
    v_add_u32 v50, s44, v2
    v_add_u32 v50, 128, v50
    v_mul_hi_u32 v51, v50, s48
    v_mul_u32_u24 v52, 10, v51
    v_sub_u32 v52, v50, v52
    v_mul_lo_u32 v53, v51, s46
    v_lshl_add_u32 v53, v52, 4, v53
    v_add_u32 v242, s47, v53
    v_mov_b32 v53, 0x7ffffff0
    v_cmp_le_u32 vcc, 640, v50
    s_nop 1
    v_cndmask_b32 v242, v242, v53, vcc
    s_waitcnt lgkmcnt(0)
    s_mov_b32 s8, s34
    s_mov_b32 s9, s35
    s_and_b32 s9, s9, 0xffff
    s_mov_b32 s10, 2621440
    s_mov_b32 s11, 0x00020000
    s_mov_b32 s12, s6
    s_mov_b32 s13, s7
    s_and_b32 s13, s13, 0xffff
    s_mov_b32 s14, 819200
    s_mov_b32 s15, 0x00020000
    s_cmp_eq_u32 s33, 8
    s_cbranch_scc0 k1_qkv_kernel_notkv
    s_mov_b32 s12, s36
    s_mov_b32 s13, s37
    s_and_b32 s13, s13, 0xffff
    s_mov_b32 s14, 25600
    s_mov_b32 s15, 0x00020000
    s_mov_b32 s16, s38
    s_mov_b32 s17, s39
    s_and_b32 s17, s17, 0xffff
    s_mov_b32 s18, 25600
    s_mov_b32 s19, 0x00020000
k1_qkv_kernel_notkv:
    s_mov_b32 s49, 0
    s_mov_b32 s50, 0
    s_mov_b32 s60, 0
    s_mov_b32 s62, 0
    s_mov_b32 s63, 0
    s_lshl_b32 s64, s42, 11
    s_mul_i32 s65, s42, 3072
    s_add_u32 s65, s65, 8192
    s_lshr_b32 s53, s42, 0
    s_and_b32 s54, s42, 0
    v_and_b32 v3, 15, v2
    v_lshrrev_b32 v4, 4, v2
    s_mul_i32 s55, s53, 16
    s_add_u32 s55, s55, s40
    v_add_u32 v5, s55, v3
    s_mul_i32 s56, s54, 80
    s_add_u32 s56, s56, s41
    v_lshl_add_u32 v6, v4, 2, s56
    s_mov_b32 s44, 1280
    v_mul_lo_u32 v7, v5, s44
    v_lshl_add_u32 v7, v6, 1, v7
    v_add_u32 v16, 20480, v7
    s_cmp_lt_u32 s60, 10
    s_cselect_b32 s61, s62, 0x7ffffff0
    s_add_u32 s60, s60, 1
    s_add_u32 s62, s62, 128
    s_add_u32 m0, s63, s64
    s_nop 0
    buffer_load_dwordx4 v10, s[8:11], s61 offen lds
    s_add_u32 m0, m0, 1024
    s_nop 0
    buffer_load_dwordx4 v11, s[8:11], s61 offen lds
    s_add_u32 m0, s63, s65
    s_nop 0
    buffer_load_dwordx4 v240, s[12:15], s49 offen lds
    s_add_u32 m0, m0, 1024
    s_nop 0
    buffer_load_dwordx4 v241, s[12:15], s49 offen lds
    s_add_u32 m0, m0, 1024
    s_nop 0
    buffer_load_dwordx4 v242, s[12:15], s49 offen lds
    s_add_u32 s49, s49, 81920
    s_add_u32 s63, s63, 20480
    s_cmp_eq_u32 s63, 81920
    s_cselect_b32 s63, 0, s63
    s_cmp_lt_u32 s60, 10
    s_cselect_b32 s61, s62, 0x7ffffff0
    s_add_u32 s60, s60, 1
    s_add_u32 s62, s62, 128
    s_add_u32 m0, s63, s64
    s_nop 0
    buffer_load_dwordx4 v10, s[8:11], s61 offen lds
    s_add_u32 m0, m0, 1024
    s_nop 0
    buffer_load_dwordx4 v11, s[8:11], s61 offen lds
    s_add_u32 m0, s63, s65
    s_nop 0
    buffer_load_dwordx4 v240, s[12:15], s49 offen lds
    s_add_u32 m0, m0, 1024
    s_nop 0
    buffer_load_dwordx4 v241, s[12:15], s49 offen lds
    s_add_u32 m0, m0, 1024
    s_nop 0
    buffer_load_dwordx4 v242, s[12:15], s49 offen lds
    s_add_u32 s49, s49, 81920
    s_add_u32 s63, s63, 20480
    s_cmp_eq_u32 s63, 81920
    s_cselect_b32 s63, 0, s63
    s_cmp_lt_u32 s60, 10
    s_cselect_b32 s61, s62, 0x7ffffff0
    s_add_u32 s60, s60, 1
    s_add_u32 s62, s62, 128
    s_add_u32 m0, s63, s64
    s_nop 0
    buffer_load_dwordx4 v10, s[8:11], s61 offen lds
    s_add_u32 m0, m0, 1024
    s_nop 0
    buffer_load_dwordx4 v11, s[8:11], s61 offen lds
    s_add_u32 m0, s63, s65
    s_nop 0
    buffer_load_dwordx4 v240, s[12:15], s49 offen lds
    s_add_u32 m0, m0, 1024
    s_nop 0
    buffer_load_dwordx4 v241, s[12:15], s49 offen lds
    s_add_u32 m0, m0, 1024
    s_nop 0
    buffer_load_dwordx4 v242, s[12:15], s49 offen lds
    s_add_u32 s49, s49, 81920
    s_add_u32 s63, s63, 20480
    s_cmp_eq_u32 s63, 81920
    s_cselect_b32 s63, 0, s63
    s_lshr_b32 s53, s42, 0
    s_and_b32 s54, s42, 0
    v_and_b32 v3, 15, v2
    v_lshrrev_b32 v4, 4, v2
    v_and_b32 v22, 7, v3
    v_xor_b32 v22, v22, v4
    v_lshlrev_b32 v22, 4, v22
    v_lshl_add_u32 v22, v3, 7, v22
    s_mul_i32 s55, s53, 2048
    v_add_u32 v22, s55, v22
    v_xor_b32 v23, 64, v22
    v_lshrrev_b32 v24, 2, v3
    v_lshl_add_u32 v24, v4, 3, v24
    v_mul_u32_u24 v24, 160, v24
    v_and_b32 v25, 3, v2
    v_lshl_add_u32 v24, v25, 3, v24
    s_mul_i32 s55, s54, 160
    s_add_u32 s55, s55, 8192
    v_add_u32 v24, s55, v24
    v_mov_b32 v72, 0
    v_mov_b32 v73, 0
    v_mov_b32 v74, 0
    v_mov_b32 v75, 0
    v_mov_b32 v76, 0
    v_mov_b32 v77, 0
    v_mov_b32 v78, 0
    v_mov_b32 v79, 0
    v_mov_b32 v80, 0
    v_mov_b32 v81, 0
    v_mov_b32 v82, 0
    v_mov_b32 v83, 0
    v_mov_b32 v84, 0
    v_mov_b32 v85, 0
    v_mov_b32 v86, 0
    v_mov_b32 v87, 0
    v_mov_b32 v88, 0
    v_mov_b32 v89, 0
    v_mov_b32 v90, 0
    v_mov_b32 v91, 0
    v_mov_b32 v60, 0
    v_mov_b32 v62, 0
    v_mov_b32 v64, 0x3f803f80
    v_mov_b32 v40, 0
    v_mov_b32 v41, 0
    v_mov_b32 v42, 0
    v_mov_b32 v43, 0
    v_mov_b32 v44, 0
    s_mov_b32 s66, 0
    s_mov_b32 s51, 10
    s_cmp_eq_u32 s33, 8
    s_cbranch_scc1 k1_qkv_kernel_kv
k1_qkv_kernel_loop:
    s_waitcnt vmcnt(10)
    s_barrier
    v_add_u32 v26, s66, v22
    v_add_u32 v27, s66, v23
    v_add_u32 v28, s66, v24
    ds_read_b128 v[92:95], v26 offset:0
    ds_read_b64_tr_b16 v[96:97], v28 offset:0
    ds_read_b64_tr_b16 v[98:99], v28 offset:640
    ds_read_b64_tr_b16 v[100:101], v28 offset:32
    ds_read_b64_tr_b16 v[102:103], v28 offset:672
    ds_read_b64_tr_b16 v[104:105], v28 offset:64
    ds_read_b64_tr_b16 v[106:107], v28 offset:704
    ds_read_b64_tr_b16 v[108:109], v28 offset:96
    ds_read_b64_tr_b16 v[110:111], v28 offset:736
    ds_read_b64_tr_b16 v[112:113], v28 offset:128
    ds_read_b64_tr_b16 v[114:115], v28 offset:768
    ds_read_b128 v[116:119], v27 offset:0
    ds_read_b64_tr_b16 v[120:121], v28 offset:5120
    ds_read_b64_tr_b16 v[122:123], v28 offset:5760
    ds_read_b64_tr_b16 v[124:125], v28 offset:5152
    ds_read_b64_tr_b16 v[126:127], v28 offset:5792
    ds_read_b64_tr_b16 v[128:129], v28 offset:5184
    ds_read_b64_tr_b16 v[130:131], v28 offset:5824
    ds_read_b64_tr_b16 v[132:133], v28 offset:5216
    ds_read_b64_tr_b16 v[134:135], v28 offset:5856
    ds_read_b64_tr_b16 v[136:137], v28 offset:5248
    ds_read_b64_tr_b16 v[138:139], v28 offset:5888
    s_cmp_lt_u32 s60, 10
    s_cselect_b32 s61, s62, 0x7ffffff0
    s_add_u32 s60, s60, 1
    s_add_u32 s62, s62, 128
    s_add_u32 m0, s63, s64
    s_nop 0
    buffer_load_dwordx4 v10, s[8:11], s61 offen lds
    s_add_u32 m0, m0, 1024
    s_nop 0
    buffer_load_dwordx4 v11, s[8:11], s61 offen lds
    s_add_u32 m0, s63, s65
    s_nop 0
    buffer_load_dwordx4 v240, s[12:15], s49 offen lds
    s_add_u32 m0, m0, 1024
    s_nop 0
    buffer_load_dwordx4 v241, s[12:15], s49 offen lds
    s_add_u32 m0, m0, 1024
    s_nop 0
    buffer_load_dwordx4 v242, s[12:15], s49 offen lds
    s_add_u32 s49, s49, 81920
    s_add_u32 s63, s63, 20480
    s_cmp_eq_u32 s63, 81920
    s_cselect_b32 s63, 0, s63
    s_waitcnt lgkmcnt(11)
    v_mfma_f32_16x16x32_bf16 v[72:75], v[96:99], v[92:95], v[72:75]
    v_mfma_f32_16x16x32_bf16 v[76:79], v[100:103], v[92:95], v[76:79]
    v_mfma_f32_16x16x32_bf16 v[80:83], v[104:107], v[92:95], v[80:83]
    v_mfma_f32_16x16x32_bf16 v[84:87], v[108:111], v[92:95], v[84:87]
    v_mfma_f32_16x16x32_bf16 v[88:91], v[112:115], v[92:95], v[88:91]
    v_dot2_f32_bf16 v60, v92, v64, v60
    v_dot2_f32_bf16 v62, v92, v92, v62
    v_dot2_f32_bf16 v60, v93, v64, v60
    v_dot2_f32_bf16 v62, v93, v93, v62
    v_dot2_f32_bf16 v60, v94, v64, v60
    v_dot2_f32_bf16 v62, v94, v94, v62
    v_dot2_f32_bf16 v60, v95, v64, v60
    v_dot2_f32_bf16 v62, v95, v95, v62
    v_dot2_f32_bf16 v40, v96, v64, v40
    v_dot2_f32_bf16 v40, v97, v64, v40
    v_dot2_f32_bf16 v40, v98, v64, v40
    v_dot2_f32_bf16 v40, v99, v64, v40
    v_dot2_f32_bf16 v41, v100, v64, v41
    v_dot2_f32_bf16 v41, v101, v64, v41
    v_dot2_f32_bf16 v41, v102, v64, v41
    v_dot2_f32_bf16 v41, v103, v64, v41
    v_dot2_f32_bf16 v42, v104, v64, v42
    v_dot2_f32_bf16 v42, v105, v64, v42
    v_dot2_f32_bf16 v42, v106, v64, v42
    v_dot2_f32_bf16 v42, v107, v64, v42
    v_dot2_f32_bf16 v43, v108, v64, v43
    v_dot2_f32_bf16 v43, v109, v64, v43
    v_dot2_f32_bf16 v43, v110, v64, v43
    v_dot2_f32_bf16 v43, v111, v64, v43
    v_dot2_f32_bf16 v44, v112, v64, v44
    v_dot2_f32_bf16 v44, v113, v64, v44
    v_dot2_f32_bf16 v44, v114, v64, v44
    v_dot2_f32_bf16 v44, v115, v64, v44
    s_waitcnt lgkmcnt(0)
    v_mfma_f32_16x16x32_bf16 v[72:75], v[120:123], v[116:119], v[72:75]
    v_mfma_f32_16x16x32_bf16 v[76:79], v[124:127], v[116:119], v[76:79]
    v_mfma_f32_16x16x32_bf16 v[80:83], v[128:131], v[116:119], v[80:83]
    v_mfma_f32_16x16x32_bf16 v[84:87], v[132:135], v[116:119], v[84:87]
    v_mfma_f32_16x16x32_bf16 v[88:91], v[136:139], v[116:119], v[88:91]
    v_dot2_f32_bf16 v60, v116, v64, v60
    v_dot2_f32_bf16 v62, v116, v116, v62
    v_dot2_f32_bf16 v60, v117, v64, v60
    v_dot2_f32_bf16 v62, v117, v117, v62
    v_dot2_f32_bf16 v60, v118, v64, v60
    v_dot2_f32_bf16 v62, v118, v118, v62
    v_dot2_f32_bf16 v60, v119, v64, v60
    v_dot2_f32_bf16 v62, v119, v119, v62
    v_dot2_f32_bf16 v40, v120, v64, v40
    v_dot2_f32_bf16 v40, v121, v64, v40
    v_dot2_f32_bf16 v40, v122, v64, v40
    v_dot2_f32_bf16 v40, v123, v64, v40
    v_dot2_f32_bf16 v41, v124, v64, v41
    v_dot2_f32_bf16 v41, v125, v64, v41
    v_dot2_f32_bf16 v41, v126, v64, v41
    v_dot2_f32_bf16 v41, v127, v64, v41
    v_dot2_f32_bf16 v42, v128, v64, v42
    v_dot2_f32_bf16 v42, v129, v64, v42
    v_dot2_f32_bf16 v42, v130, v64, v42
    v_dot2_f32_bf16 v42, v131, v64, v42
    v_dot2_f32_bf16 v43, v132, v64, v43
    v_dot2_f32_bf16 v43, v133, v64, v43
    v_dot2_f32_bf16 v43, v134, v64, v43
    v_dot2_f32_bf16 v43, v135, v64, v43
    v_dot2_f32_bf16 v44, v136, v64, v44
    v_dot2_f32_bf16 v44, v137, v64, v44
    v_dot2_f32_bf16 v44, v138, v64, v44
    v_dot2_f32_bf16 v44, v139, v64, v44
    s_add_u32 s66, s66, 20480
    s_cmp_eq_u32 s66, 81920
    s_cselect_b32 s66, 0, s66
    s_sub_u32 s51, s51, 1
    s_cmp_lg_u32 s51, 0
    s_cbranch_scc1 k1_qkv_kernel_loop
    s_waitcnt vmcnt(0)
    s_barrier
    s_nop 7
    ds_swizzle_b32 v100, v60 offset:0x401F
    ds_swizzle_b32 v101, v62 offset:0x401F
    ds_swizzle_b32 v102, v40 offset:0x401F
    ds_swizzle_b32 v103, v41 offset:0x401F
    ds_swizzle_b32 v104, v42 offset:0x401F
    ds_swizzle_b32 v105, v43 offset:0x401F
    ds_swizzle_b32 v106, v44 offset:0x401F
    s_waitcnt lgkmcnt(0)
    v_add_f32 v60, v60, v100
    v_mov_b32 v100, v60
    v_add_f32 v62, v62, v101
    v_mov_b32 v101, v62
    v_add_f32 v40, v40, v102
    v_mov_b32 v102, v40
    v_add_f32 v41, v41, v103
    v_mov_b32 v103, v41
    v_add_f32 v42, v42, v104
    v_mov_b32 v104, v42
    v_add_f32 v43, v43, v105
    v_mov_b32 v105, v43
    v_add_f32 v44, v44, v106
    v_mov_b32 v106, v44
    s_nop 1
    v_permlane32_swap_b32 v60, v100
    v_permlane32_swap_b32 v62, v101
    v_permlane32_swap_b32 v40, v102
    v_permlane32_swap_b32 v41, v103
    v_permlane32_swap_b32 v42, v104
    v_permlane32_swap_b32 v43, v105
    v_permlane32_swap_b32 v44, v106
    s_nop 1
    v_add_f32 v60, v60, v100
    v_add_f32 v62, v62, v101
    v_add_f32 v40, v40, v102
    v_add_f32 v41, v41, v103
    v_add_f32 v42, v42, v104
    v_add_f32 v43, v43, v105
    v_add_f32 v44, v44, v106
    s_mul_i32 s57, s42, 320
    v_lshl_add_u32 v50, v3, 2, s57
    v_lshl_add_u32 v51, v4, 4, s57
    ds_write_b32 v50, v40 offset:0
    ds_write_b32 v50, v41 offset:64
    ds_write_b32 v50, v42 offset:128
    ds_write_b32 v50, v43 offset:192
    ds_write_b32 v50, v44 offset:256
    v_mul_f32 v60, 0x3acccccd, v60
    v_mul_f32 v62, 0x3acccccd, v62
    v_fma_f32 v62, -v60, v60, v62
    v_add_f32 v50, 0x3727c5ac, v62
    v_rsq_f32 v66, v50
    s_nop 0
    v_mov_b32 v62, v66
    s_waitcnt lgkmcnt(0)
    ds_read_b128 v[92:95], v51 offset:0
    ds_read_b128 v[96:99], v51 offset:64
    ds_read_b128 v[100:103], v51 offset:128
    ds_read_b128 v[104:107], v51 offset:192
    ds_read_b128 v[108:111], v51 offset:256
    s_waitcnt lgkmcnt(0)
    v_fma_f32 v72, -v60, v92, v72
    v_mul_f32 v72, v72, v62
    v_fma_f32 v73, -v60, v93, v73
    v_mul_f32 v73, v73, v62
    v_fma_f32 v74, -v60, v94, v74
    v_mul_f32 v74, v74, v62
    v_fma_f32 v75, -v60, v95, v75
    v_mul_f32 v75, v75, v62
    v_fma_f32 v76, -v60, v96, v76
    v_mul_f32 v76, v76, v62
    v_fma_f32 v77, -v60, v97, v77
    v_mul_f32 v77, v77, v62
    v_fma_f32 v78, -v60, v98, v78
    v_mul_f32 v78, v78, v62
    v_fma_f32 v79, -v60, v99, v79
    v_mul_f32 v79, v79, v62
    v_fma_f32 v80, -v60, v100, v80
    v_mul_f32 v80, v80, v62
    v_fma_f32 v81, -v60, v101, v81
    v_mul_f32 v81, v81, v62
    v_fma_f32 v82, -v60, v102, v82
    v_mul_f32 v82, v82, v62
    v_fma_f32 v83, -v60, v103, v83
    v_mul_f32 v83, v83, v62
    v_fma_f32 v84, -v60, v104, v84
    v_mul_f32 v84, v84, v62
    v_fma_f32 v85, -v60, v105, v85
    v_mul_f32 v85, v85, v62
    v_fma_f32 v86, -v60, v106, v86
    v_mul_f32 v86, v86, v62
    v_fma_f32 v87, -v60, v107, v87
    v_mul_f32 v87, v87, v62
    v_fma_f32 v88, -v60, v108, v88
    v_mul_f32 v88, v88, v62
    v_fma_f32 v89, -v60, v109, v89
    v_mul_f32 v89, v89, v62
    v_fma_f32 v90, -v60, v110, v90
    v_mul_f32 v90, v90, v62
    v_fma_f32 v91, -v60, v111, v91
    v_mul_f32 v91, v91, v62
    s_waitcnt vmcnt(0)
    s_mov_b32 s16, s4
    s_mov_b32 s17, s5
    s_and_b32 s17, s17, 0xffff
    s_mov_b32 s18, 2621440
    s_mov_b32 s19, 0x00020000
    v_mul_f32 v72, 0x3ea52b5c, v72
    v_mul_f32 v73, 0x3ea52b5c, v73
    v_mul_f32 v74, 0x3ea52b5c, v74
    v_mul_f32 v75, 0x3ea52b5c, v75
    v_mul_f32 v76, 0x3ea52b5c, v76
    v_mul_f32 v77, 0x3ea52b5c, v77
    v_mul_f32 v78, 0x3ea52b5c, v78
    v_mul_f32 v79, 0x3ea52b5c, v79
    v_mul_f32 v80, 0x3ea52b5c, v80
    v_mul_f32 v81, 0x3ea52b5c, v81
    v_mul_f32 v82, 0x3ea52b5c, v82
    v_mul_f32 v83, 0x3ea52b5c, v83
    v_mul_f32 v84, 0x3ea52b5c, v84
    v_mul_f32 v85, 0x3ea52b5c, v85
    v_mul_f32 v86, 0x3ea52b5c, v86
    v_mul_f32 v87, 0x3ea52b5c, v87
    v_mul_f32 v88, 0x3ea52b5c, v88
    v_mul_f32 v89, 0x3ea52b5c, v89
    v_mul_f32 v90, 0x3ea52b5c, v90
    v_mul_f32 v91, 0x3ea52b5c, v91
    v_cvt_pk_bf16_f32 v50, v72, v73
    v_cvt_pk_bf16_f32 v51, v74, v75
    buffer_store_dwordx2 v[50:51], v7, s[16:19], 0 offen offset:0
    v_cvt_pk_bf16_f32 v50, v76, v77
    v_cvt_pk_bf16_f32 v51, v78, v79
    buffer_store_dwordx2 v[50:51], v7, s[16:19], 0 offen offset:32
    v_cvt_pk_bf16_f32 v50, v80, v81
    v_cvt_pk_bf16_f32 v51, v82, v83
    buffer_store_dwordx2 v[50:51], v7, s[16:19], 0 offen offset:64
    v_cvt_pk_bf16_f32 v50, v84, v85
    v_cvt_pk_bf16_f32 v51, v86, v87
    buffer_store_dwordx2 v[50:51], v7, s[16:19], 0 offen offset:96
    v_cvt_pk_bf16_f32 v50, v88, v89
    v_cvt_pk_bf16_f32 v51, v90, v91
    buffer_store_dwordx2 v[50:51], v7, s[16:19], 0 offen offset:128
    s_waitcnt vmcnt(0)
    s_branch k1_qkv_kernel_end
k1_qkv_kernel_kv:
    s_waitcnt vmcnt(0)
    s_barrier
    s_lshl_b32 s44, s42, 8
    v_add_u32 v50, s44, v2
    v_add_u32 v50, 0, v50
    v_lshrrev_b32 v51, 4, v50
    v_and_b32 v52, 15, v50
    v_mul_u32_u24 v53, 40, v51
    v_lshl_add_u32 v53, v52, 2, v53
    v_mov_b32 v54, 0x7ffffff0
    v_cmp_gt_u32 vcc, 10, v52
    s_nop 1
    v_cndmask_b32 v240, v54, v53, vcc
    s_lshl_b32 s44, s42, 8
    v_add_u32 v50, s44, v2
    v_add_u32 v50, 64, v50
    v_lshrrev_b32 v51, 4, v50
    v_and_b32 v52, 15, v50
    v_mul_u32_u24 v53, 40, v51
    v_lshl_add_u32 v53, v52, 2, v53
    v_mov_b32 v54, 0x7ffffff0
    v_cmp_gt_u32 vcc, 10, v52
    s_nop 1
    v_cndmask_b32 v241, v54, v53, vcc
    s_lshl_b32 s44, s42, 8
    v_add_u32 v50, s44, v2
    v_add_u32 v50, 128, v50
    v_lshrrev_b32 v51, 4, v50
    v_and_b32 v52, 15, v50
    v_mul_u32_u24 v53, 40, v51
    v_lshl_add_u32 v53, v52, 2, v53
    v_mov_b32 v54, 0x7ffffff0
    v_cmp_gt_u32 vcc, 10, v52
    s_nop 1
    v_cndmask_b32 v242, v54, v53, vcc
    s_lshl_b32 s44, s42, 8
    v_add_u32 v50, s44, v2
    v_add_u32 v50, 192, v50
    v_lshrrev_b32 v51, 4, v50
    v_and_b32 v52, 15, v50
    v_mul_u32_u24 v53, 40, v51
    v_lshl_add_u32 v53, v52, 2, v53
    v_mov_b32 v54, 0x7ffffff0
    v_cmp_gt_u32 vcc, 10, v52
    s_nop 1
    v_cndmask_b32 v243, v54, v53, vcc
    s_mov_b32 s49, 0
    s_mov_b32 s60, 0
    s_mov_b32 s62, 0
    s_mov_b32 s63, 0
    s_lshl_b32 s65, s42, 10
    s_add_u32 s65, s65, 8192
    s_cmp_lt_u32 s60, 10
    s_cselect_b32 s61, s62, 0x7ffffff0
    s_add_u32 s60, s60, 1
    s_add_u32 s62, s62, 128
    s_add_u32 m0, s63, s64
    s_nop 0
    buffer_load_dwordx4 v10, s[8:11], s61 offen lds
    s_add_u32 m0, m0, 1024
    s_nop 0
    buffer_load_dwordx4 v11, s[8:11], s61 offen lds
    s_add_u32 m0, s63, s65
    s_nop 0
    buffer_load_dword v240, s[12:15], s49 offen lds
    s_add_u32 m0, m0, 256
    s_nop 0
    buffer_load_dword v241, s[12:15], s49 offen lds
    s_add_u32 m0, m0, 256
    s_nop 0
    buffer_load_dword v242, s[12:15], s49 offen lds
    s_add_u32 m0, m0, 256
    s_nop 0
    buffer_load_dword v243, s[12:15], s49 offen lds
    s_add_u32 m0, m0, 256
    s_add_u32 m0, m0, 3072
    s_nop 0
    buffer_load_dword v240, s[16:19], s49 offen lds
    s_add_u32 m0, m0, 256
    s_nop 0
    buffer_load_dword v241, s[16:19], s49 offen lds
    s_add_u32 m0, m0, 256
    s_nop 0
    buffer_load_dword v242, s[16:19], s49 offen lds
    s_add_u32 m0, m0, 256
    s_nop 0
    buffer_load_dword v243, s[16:19], s49 offen lds
    s_add_u32 m0, m0, 256
    s_add_u32 s49, s49, 2560
    s_add_u32 s63, s63, 20480
    s_cmp_eq_u32 s63, 81920
    s_cselect_b32 s63, 0, s63
    s_cmp_lt_u32 s60, 10
    s_cselect_b32 s61, s62, 0x7ffffff0
    s_add_u32 s60, s60, 1
    s_add_u32 s62, s62, 128
    s_add_u32 m0, s63, s64
    s_nop 0
    buffer_load_dwordx4 v10, s[8:11], s61 offen lds
    s_add_u32 m0, m0, 1024
    s_nop 0
    buffer_load_dwordx4 v11, s[8:11], s61 offen lds
    s_add_u32 m0, s63, s65
    s_nop 0
    buffer_load_dword v240, s[12:15], s49 offen lds
    s_add_u32 m0, m0, 256
    s_nop 0
    buffer_load_dword v241, s[12:15], s49 offen lds
    s_add_u32 m0, m0, 256
    s_nop 0
    buffer_load_dword v242, s[12:15], s49 offen lds
    s_add_u32 m0, m0, 256
    s_nop 0
    buffer_load_dword v243, s[12:15], s49 offen lds
    s_add_u32 m0, m0, 256
    s_add_u32 m0, m0, 3072
    s_nop 0
    buffer_load_dword v240, s[16:19], s49 offen lds
    s_add_u32 m0, m0, 256
    s_nop 0
    buffer_load_dword v241, s[16:19], s49 offen lds
    s_add_u32 m0, m0, 256
    s_nop 0
    buffer_load_dword v242, s[16:19], s49 offen lds
    s_add_u32 m0, m0, 256
    s_nop 0
    buffer_load_dword v243, s[16:19], s49 offen lds
    s_add_u32 m0, m0, 256
    s_add_u32 s49, s49, 2560
    s_add_u32 s63, s63, 20480
    s_cmp_eq_u32 s63, 81920
    s_cselect_b32 s63, 0, s63
    s_cmp_lt_u32 s60, 10
    s_cselect_b32 s61, s62, 0x7ffffff0
    s_add_u32 s60, s60, 1
    s_add_u32 s62, s62, 128
    s_add_u32 m0, s63, s64
    s_nop 0
    buffer_load_dwordx4 v10, s[8:11], s61 offen lds
    s_add_u32 m0, m0, 1024
    s_nop 0
    buffer_load_dwordx4 v11, s[8:11], s61 offen lds
    s_add_u32 m0, s63, s65
    s_nop 0
    buffer_load_dword v240, s[12:15], s49 offen lds
    s_add_u32 m0, m0, 256
    s_nop 0
    buffer_load_dword v241, s[12:15], s49 offen lds
    s_add_u32 m0, m0, 256
    s_nop 0
    buffer_load_dword v242, s[12:15], s49 offen lds
    s_add_u32 m0, m0, 256
    s_nop 0
    buffer_load_dword v243, s[12:15], s49 offen lds
    s_add_u32 m0, m0, 256
    s_add_u32 m0, m0, 3072
    s_nop 0
    buffer_load_dword v240, s[16:19], s49 offen lds
    s_add_u32 m0, m0, 256
    s_nop 0
    buffer_load_dword v241, s[16:19], s49 offen lds
    s_add_u32 m0, m0, 256
    s_nop 0
    buffer_load_dword v242, s[16:19], s49 offen lds
    s_add_u32 m0, m0, 256
    s_nop 0
    buffer_load_dword v243, s[16:19], s49 offen lds
    s_add_u32 m0, m0, 256
    s_add_u32 s49, s49, 2560
    s_add_u32 s63, s63, 20480
    s_cmp_eq_u32 s63, 81920
    s_cselect_b32 s63, 0, s63
    v_lshrrev_b32 v24, 2, v3
    v_lshl_add_u32 v24, v4, 3, v24
    v_lshlrev_b32 v24, 6, v24
    v_lshl_add_u32 v24, v25, 3, v24
    v_add_u32 v24, 8192, v24
k1_qkv_kernel_kvloop:
    s_waitcnt vmcnt(20)
    s_barrier
    v_add_u32 v26, s66, v22
    v_add_u32 v27, s66, v23
    v_add_u32 v28, s66, v24
    ds_read_b128 v[92:95], v26 offset:0
    ds_read_b64_tr_b16 v[96:97], v28 offset:0
    ds_read_b64_tr_b16 v[98:99], v28 offset:256
    ds_read_b64_tr_b16 v[100:101], v28 offset:32
    ds_read_b64_tr_b16 v[102:103], v28 offset:288
    ds_read_b64_tr_b16 v[104:105], v28 offset:4096
    ds_read_b64_tr_b16 v[106:107], v28 offset:4352
    ds_read_b64_tr_b16 v[108:109], v28 offset:4128
    ds_read_b64_tr_b16 v[110:111], v28 offset:4384
    ds_read_b128 v[112:115], v27 offset:0
    ds_read_b64_tr_b16 v[116:117], v28 offset:2048
    ds_read_b64_tr_b16 v[118:119], v28 offset:2304
    ds_read_b64_tr_b16 v[120:121], v28 offset:2080
    ds_read_b64_tr_b16 v[122:123], v28 offset:2336
    ds_read_b64_tr_b16 v[124:125], v28 offset:6144
    ds_read_b64_tr_b16 v[126:127], v28 offset:6400
    ds_read_b64_tr_b16 v[128:129], v28 offset:6176
    ds_read_b64_tr_b16 v[130:131], v28 offset:6432
    s_cmp_lt_u32 s60, 10
    s_cselect_b32 s61, s62, 0x7ffffff0
    s_add_u32 s60, s60, 1
    s_add_u32 s62, s62, 128
    s_add_u32 m0, s63, s64
    s_nop 0
    buffer_load_dwordx4 v10, s[8:11], s61 offen lds
    s_add_u32 m0, m0, 1024
    s_nop 0
    buffer_load_dwordx4 v11, s[8:11], s61 offen lds
    s_add_u32 m0, s63, s65
    s_nop 0
    buffer_load_dword v240, s[12:15], s49 offen lds
    s_add_u32 m0, m0, 256
    s_nop 0
    buffer_load_dword v241, s[12:15], s49 offen lds
    s_add_u32 m0, m0, 256
    s_nop 0
    buffer_load_dword v242, s[12:15], s49 offen lds
    s_add_u32 m0, m0, 256
    s_nop 0
    buffer_load_dword v243, s[12:15], s49 offen lds
    s_add_u32 m0, m0, 256
    s_add_u32 m0, m0, 3072
    s_nop 0
    buffer_load_dword v240, s[16:19], s49 offen lds
    s_add_u32 m0, m0, 256
    s_nop 0
    buffer_load_dword v241, s[16:19], s49 offen lds
    s_add_u32 m0, m0, 256
    s_nop 0
    buffer_load_dword v242, s[16:19], s49 offen lds
    s_add_u32 m0, m0, 256
    s_nop 0
    buffer_load_dword v243, s[16:19], s49 offen lds
    s_add_u32 m0, m0, 256
    s_add_u32 s49, s49, 2560
    s_add_u32 s63, s63, 20480
    s_cmp_eq_u32 s63, 81920
    s_cselect_b32 s63, 0, s63
    s_waitcnt lgkmcnt(9)
    v_mfma_f32_16x16x32_bf16 v[72:75], v[96:99], v[92:95], v[72:75]
    v_mfma_f32_16x16x32_bf16 v[76:79], v[100:103], v[92:95], v[76:79]
    v_mfma_f32_16x16x32_bf16 v[80:83], v[104:107], v[92:95], v[80:83]
    v_mfma_f32_16x16x32_bf16 v[84:87], v[108:111], v[92:95], v[84:87]
    v_dot2_f32_bf16 v60, v92, v64, v60
    v_dot2_f32_bf16 v62, v92, v92, v62
    v_dot2_f32_bf16 v60, v93, v64, v60
    v_dot2_f32_bf16 v62, v93, v93, v62
    v_dot2_f32_bf16 v60, v94, v64, v60
    v_dot2_f32_bf16 v62, v94, v94, v62
    v_dot2_f32_bf16 v60, v95, v64, v60
    v_dot2_f32_bf16 v62, v95, v95, v62
    v_dot2_f32_bf16 v40, v96, v64, v40
    v_dot2_f32_bf16 v40, v97, v64, v40
    v_dot2_f32_bf16 v40, v98, v64, v40
    v_dot2_f32_bf16 v40, v99, v64, v40
    v_dot2_f32_bf16 v41, v100, v64, v41
    v_dot2_f32_bf16 v41, v101, v64, v41
    v_dot2_f32_bf16 v41, v102, v64, v41
    v_dot2_f32_bf16 v41, v103, v64, v41
    v_dot2_f32_bf16 v42, v104, v64, v42
    v_dot2_f32_bf16 v42, v105, v64, v42
    v_dot2_f32_bf16 v42, v106, v64, v42
    v_dot2_f32_bf16 v42, v107, v64, v42
    v_dot2_f32_bf16 v43, v108, v64, v43
    v_dot2_f32_bf16 v43, v109, v64, v43
    v_dot2_f32_bf16 v43, v110, v64, v43
    v_dot2_f32_bf16 v43, v111, v64, v43
    s_waitcnt lgkmcnt(0)
    v_mfma_f32_16x16x32_bf16 v[72:75], v[116:119], v[112:115], v[72:75]
    v_mfma_f32_16x16x32_bf16 v[76:79], v[120:123], v[112:115], v[76:79]
    v_mfma_f32_16x16x32_bf16 v[80:83], v[124:127], v[112:115], v[80:83]
    v_mfma_f32_16x16x32_bf16 v[84:87], v[128:131], v[112:115], v[84:87]
    v_dot2_f32_bf16 v60, v112, v64, v60
    v_dot2_f32_bf16 v62, v112, v112, v62
    v_dot2_f32_bf16 v60, v113, v64, v60
    v_dot2_f32_bf16 v62, v113, v113, v62
    v_dot2_f32_bf16 v60, v114, v64, v60
    v_dot2_f32_bf16 v62, v114, v114, v62
    v_dot2_f32_bf16 v60, v115, v64, v60
    v_dot2_f32_bf16 v62, v115, v115, v62
    v_dot2_f32_bf16 v40, v116, v64, v40
    v_dot2_f32_bf16 v40, v117, v64, v40
    v_dot2_f32_bf16 v40, v118, v64, v40
    v_dot2_f32_bf16 v40, v119, v64, v40
    v_dot2_f32_bf16 v41, v120, v64, v41
    v_dot2_f32_bf16 v41, v121, v64, v41
    v_dot2_f32_bf16 v41, v122, v64, v41
    v_dot2_f32_bf16 v41, v123, v64, v41
    v_dot2_f32_bf16 v42, v124, v64, v42
    v_dot2_f32_bf16 v42, v125, v64, v42
    v_dot2_f32_bf16 v42, v126, v64, v42
    v_dot2_f32_bf16 v42, v127, v64, v42
    v_dot2_f32_bf16 v43, v128, v64, v43
    v_dot2_f32_bf16 v43, v129, v64, v43
    v_dot2_f32_bf16 v43, v130, v64, v43
    v_dot2_f32_bf16 v43, v131, v64, v43
    s_add_u32 s66, s66, 20480
    s_cmp_eq_u32 s66, 81920
    s_cselect_b32 s66, 0, s66
    s_sub_u32 s51, s51, 1
    s_cmp_lg_u32 s51, 0
    s_cbranch_scc1 k1_qkv_kernel_kvloop
    s_waitcnt vmcnt(0)
    s_barrier
    s_nop 7
    ds_swizzle_b32 v100, v60 offset:0x401F
    ds_swizzle_b32 v101, v62 offset:0x401F
    ds_swizzle_b32 v102, v40 offset:0x401F
    ds_swizzle_b32 v103, v41 offset:0x401F
    ds_swizzle_b32 v104, v42 offset:0x401F
    ds_swizzle_b32 v105, v43 offset:0x401F
    ds_swizzle_b32 v106, v44 offset:0x401F
    s_waitcnt lgkmcnt(0)
    v_add_f32 v60, v60, v100
    v_mov_b32 v100, v60
    v_add_f32 v62, v62, v101
    v_mov_b32 v101, v62
    v_add_f32 v40, v40, v102
    v_mov_b32 v102, v40
    v_add_f32 v41, v41, v103
    v_mov_b32 v103, v41
    v_add_f32 v42, v42, v104
    v_mov_b32 v104, v42
    v_add_f32 v43, v43, v105
    v_mov_b32 v105, v43
    v_add_f32 v44, v44, v106
    v_mov_b32 v106, v44
    s_nop 1
    v_permlane32_swap_b32 v60, v100
    v_permlane32_swap_b32 v62, v101
    v_permlane32_swap_b32 v40, v102
    v_permlane32_swap_b32 v41, v103
    v_permlane32_swap_b32 v42, v104
    v_permlane32_swap_b32 v43, v105
    v_permlane32_swap_b32 v44, v106
    s_nop 1
    v_add_f32 v60, v60, v100
    v_add_f32 v62, v62, v101
    v_add_f32 v40, v40, v102
    v_add_f32 v41, v41, v103
    v_add_f32 v42, v42, v104
    v_add_f32 v43, v43, v105
    v_add_f32 v44, v44, v106
    s_mul_i32 s57, s42, 320
    v_lshl_add_u32 v50, v3, 2, s57
    v_lshl_add_u32 v51, v4, 4, s57
    ds_write_b32 v50, v40 offset:0
    ds_write_b32 v50, v41 offset:64
    ds_write_b32 v50, v42 offset:128
    ds_write_b32 v50, v43 offset:192
    ds_write_b32 v50, v44 offset:256
    v_mul_f32 v60, 0x3acccccd, v60
    v_mul_f32 v62, 0x3acccccd, v62
    v_fma_f32 v62, -v60, v60, v62
    v_add_f32 v50, 0x3727c5ac, v62
    v_rsq_f32 v66, v50
    s_nop 0
    v_mov_b32 v62, v66
    s_waitcnt lgkmcnt(0)
    ds_read_b128 v[92:95], v51 offset:0
    ds_read_b128 v[96:99], v51 offset:64
    ds_read_b128 v[100:103], v51 offset:128
    ds_read_b128 v[104:107], v51 offset:192
    ds_read_b128 v[108:111], v51 offset:256
    s_waitcnt lgkmcnt(0)
    v_fma_f32 v72, -v60, v92, v72
    v_mul_f32 v72, v72, v62
    v_fma_f32 v73, -v60, v93, v73
    v_mul_f32 v73, v73, v62
    v_fma_f32 v74, -v60, v94, v74
    v_mul_f32 v74, v74, v62
    v_fma_f32 v75, -v60, v95, v75
    v_mul_f32 v75, v75, v62
    v_fma_f32 v76, -v60, v96, v76
    v_mul_f32 v76, v76, v62
    v_fma_f32 v77, -v60, v97, v77
    v_mul_f32 v77, v77, v62
    v_fma_f32 v78, -v60, v98, v78
    v_mul_f32 v78, v78, v62
    v_fma_f32 v79, -v60, v99, v79
    v_mul_f32 v79, v79, v62
    v_fma_f32 v80, -v60, v100, v80
    v_mul_f32 v80, v80, v62
    v_fma_f32 v81, -v60, v101, v81
    v_mul_f32 v81, v81, v62
    v_fma_f32 v82, -v60, v102, v82
    v_mul_f32 v82, v82, v62
    v_fma_f32 v83, -v60, v103, v83
    v_mul_f32 v83, v83, v62
    v_fma_f32 v84, -v60, v104, v84
    v_mul_f32 v84, v84, v62
    v_fma_f32 v85, -v60, v105, v85
    v_mul_f32 v85, v85, v62
    v_fma_f32 v86, -v60, v106, v86
    v_mul_f32 v86, v86, v62
    v_fma_f32 v87, -v60, v107, v87
    v_mul_f32 v87, v87, v62
    v_fma_f32 v88, -v60, v108, v88
    v_mul_f32 v88, v88, v62
    v_fma_f32 v89, -v60, v109, v89
    v_mul_f32 v89, v89, v62
    v_fma_f32 v90, -v60, v110, v90
    v_mul_f32 v90, v90, v62
    v_fma_f32 v91, -v60, v111, v91
    v_mul_f32 v91, v91, v62
    s_add_u32 s16, s4, 3145728
    s_addc_u32 s17, s5, 0
    s_and_b32 s17, s17, 0xffff
    s_mov_b32 s18, 131072
    s_mov_b32 s19, 0x00020000
    v_lshrrev_b32 v50, 5, v5
    v_lshlrev_b32 v50, 11, v50
    v_and_b32 v51, 31, v5
    v_lshl_add_u32 v50, v51, 4, v50
    v_lshrrev_b32 v51, 1, v4
    v_lshl_add_u32 v50, v51, 9, v50
    v_and_b32 v51, 1, v4
    v_lshl_add_u32 v50, v51, 3, v50
    v_cvt_pk_bf16_f32 v52, v72, v73
    v_cvt_pk_bf16_f32 v53, v74, v75
    buffer_store_dwordx2 v[52:53], v50, s[16:19], 0 offen offset:0
    v_cvt_pk_bf16_f32 v52, v76, v77
    v_cvt_pk_bf16_f32 v53, v78, v79
    buffer_store_dwordx2 v[52:53], v50, s[16:19], 0 offen offset:1024
    s_add_u32 s16, s4, 3407872
    s_addc_u32 s17, s5, 0
    s_and_b32 s17, s17, 0xffff
    s_mov_b32 s18, 131072
    s_mov_b32 s19, 0x00020000
    v_lshrrev_b32 v50, 4, v5
    v_lshlrev_b32 v50, 10, v50
    v_bfe_u32 v51, v5, 2, 1
    v_lshl_add_u32 v50, v51, 9, v50
    v_and_b32 v51, 3, v5
    v_bfe_u32 v52, v5, 3, 1
    v_lshl_add_u32 v51, v52, 2, v51
    v_lshl_add_u32 v50, v51, 1, v50
    v_lshl_add_u32 v50, v4, 6, v50
    v_cmp_eq_u32 vcc, 1, v4
    s_nop 1
    v_cndmask_b32 v84, v84, 1.0, vcc
    v_cvt_pk_bf16_f32 v51, v80, v80
    buffer_store_short v51, v50, s[16:19], 0 offen offset:0
    v_cvt_pk_bf16_f32 v51, v81, v81
    buffer_store_short v51, v50, s[16:19], 0 offen offset:16
    v_cvt_pk_bf16_f32 v51, v82, v82
    buffer_store_short v51, v50, s[16:19], 0 offen offset:32
    v_cvt_pk_bf16_f32 v51, v83, v83
    buffer_store_short v51, v50, s[16:19], 0 offen offset:48
    v_cvt_pk_bf16_f32 v51, v84, v84
    buffer_store_short v51, v50, s[16:19], 0 offen offset:256
    v_cvt_pk_bf16_f32 v51, v85, v85
    buffer_store_short v51, v50, s[16:19], 0 offen offset:272
    v_cvt_pk_bf16_f32 v51, v86, v86
    buffer_store_short v51, v50, s[16:19], 0 offen offset:288
    v_cvt_pk_bf16_f32 v51, v87, v87
    buffer_store_short v51, v50, s[16:19], 0 offen offset:304
k1_qkv_kernel_end:
    s_endpgm
.globl k2_attn_kernel
.p2align 8
.type k2_attn_kernel,@function
k2_attn_kernel:
    s_cmp_ge_u32 s2, 256
    s_cbranch_scc1 k2_attn_kernel_end
    s_load_dwordx2 s[4:5], s[0:1], 96
    v_lshrrev_b32 v1, 6, v0
    v_and_b32 v2, 63, v0
    v_readfirstlane_b32 s42, v1
    s_lshr_b32 s32, s2, 2
    s_and_b32 s33, s2, 3
    s_lshl_b32 s33, s33, 3
    s_and_b32 s43, s42, 7
    s_add_u32 s33, s33, s43
    s_lshr_b32 s43, s42, 3
    s_waitcnt lgkmcnt(0)
    s_mov_b32 s8, s4
    s_mov_b32 s9, s5
    s_and_b32 s9, s9, 0xffff
    s_mov_b32 s10, 2621440
    s_mov_b32 s11, 0x00020000
    s_add_u32 s12, s4, 3145728
    s_addc_u32 s13, s5, 0
    s_and_b32 s13, s13, 0xffff
    s_mov_b32 s14, 131072
    s_mov_b32 s15, 0x00020000
    s_add_u32 s16, s4, 3407872
    s_addc_u32 s17, s5, 0
    s_and_b32 s17, s17, 0xffff
    s_mov_b32 s18, 131072
    s_mov_b32 s19, 0x00020000
    s_add_u32 s20, s4, 4194304
    s_addc_u32 s21, s5, 0
    s_and_b32 s21, s21, 0xffff
    s_mov_b32 s22, 2621440
    s_mov_b32 s23, 0x00020000
    v_lshrrev_b32 v3, 9, v0
    v_and_b32 v4, 511, v0
    v_lshlrev_b32 v4, 4, v4
    v_lshl_add_u32 v116, v3, 16, v4
    v_lshl_add_u32 v117, v3, 15, v4
    s_mov_b32 s48, 0
    v_add_u32 v118, 8192, v116
    buffer_load_dwordx4 v[100:103], v116, s[12:15], s48 offen
    buffer_load_dwordx4 v[104:107], v118, s[12:15], s48 offen
    buffer_load_dwordx4 v[108:111], v116, s[16:19], s48 offen
    buffer_load_dwordx4 v[112:115], v118, s[16:19], s48 offen
    s_add_u32 s48, s48, 16384
    v_and_b32 v4, 31, v2
    v_lshrrev_b32 v5, 5, v2
    s_lshl_b32 s34, s32, 5
    v_add_u32 v6, s34, v4
    s_movk_i32 s35, 1280
    v_mul_lo_u32 v6, v6, s35
    s_mul_i32 s36, s33, 40
    v_add_u32 v6, s36, v6
    v_lshl_add_u32 v7, v5, 4, v6
    buffer_load_dwordx2 v[8:9], v7, s[8:11], 0 offen
    buffer_load_dwordx2 v[10:11], v7, s[8:11], 0 offen offset:8
    buffer_load_dwordx2 v[12:13], v6, s[8:11], 0 offen offset:32
    v_mov_b32 v14, 0
    v_mov_b32 v15, 0
    v_mov_b32 v32, 0
    v_mov_b32 v48, 0
    v_mov_b32 v33, 0
    v_mov_b32 v49, 0
    v_mov_b32 v34, 0
    v_mov_b32 v50, 0
    v_mov_b32 v35, 0
    v_mov_b32 v51, 0
    v_mov_b32 v36, 0
    v_mov_b32 v52, 0
    v_mov_b32 v37, 0
    v_mov_b32 v53, 0
    v_mov_b32 v38, 0
    v_mov_b32 v54, 0
    v_mov_b32 v39, 0
    v_mov_b32 v55, 0
    v_mov_b32 v40, 0
    v_mov_b32 v56, 0
    v_mov_b32 v41, 0
    v_mov_b32 v57, 0
    v_mov_b32 v42, 0
    v_mov_b32 v58, 0
    v_mov_b32 v43, 0
    v_mov_b32 v59, 0
    v_mov_b32 v44, 0
    v_mov_b32 v60, 0
    v_mov_b32 v45, 0
    v_mov_b32 v61, 0
    v_mov_b32 v46, 0
    v_mov_b32 v62, 0
    v_mov_b32 v47, 0
    v_mov_b32 v63, 0
    v_mov_b32 v96, 0xff800000
    v_mov_b32 v95, 0xff800000
    s_lshl_b32 s44, s43, 15
    v_lshlrev_b32 v97, 4, v2
    v_add_u32 v97, s44, v97
    s_waitcnt vmcnt(0)
    v_cmp_gt_u32 vcc, 32, v2
    s_nop 1
    v_cndmask_b32 v12, 0, v12, vcc
    v_cndmask_b32 v13, 0, v13, vcc
    ds_write_b128 v117, v[100:103]
    ds_write_b128 v117, v[104:107] offset:8192
    ds_write_b128 v117, v[108:111] offset:16384
    ds_write_b128 v117, v[112:115] offset:24576
    buffer_load_dwordx4 v[100:103], v116, s[12:15], s48 offen
    buffer_load_dwordx4 v[104:107], v118, s[12:15], s48 offen
    buffer_load_dwordx4 v[108:111], v116, s[16:19], s48 offen
    buffer_load_dwordx4 v[112:115], v118, s[16:19], s48 offen
    s_add_u32 s48, s48, 16384
    s_waitcnt lgkmcnt(0)
    s_barrier
    ds_read_b128 v[120:123], v97
    ds_read_b128 v[124:127], v97 offset:1024
    s_waitcnt lgkmcnt(0)
    v_mfma_f32_32x32x16_bf16 v[16:31], v[120:123], v[8:11], v[32:47]
    v_mfma_f32_32x32x16_bf16 v[16:31], v[124:127], v[12:15], v[16:31]
    s_mov_b32 s50, 0
k2_attn_kernel_loop:
    s_and_b32 s57, s50, 7
    s_cmp_lg_u32 s57, 0
    s_cbranch_scc1 k2_attn_kernel_p0_nochunk
    s_barrier
k2_attn_kernel_p0_nochunk:
    s_lshr_b32 s56, s50, 3
    s_and_b32 s56, s56, 1
    s_lshl_b32 s56, s56, 16
    s_and_b32 s58, s50, 7
    s_lshl_b32 s58, s58, 11
    s_add_u32 s58, s58, s56
    v_add_u32 v94, s58, v97
    ds_read_b128 v[68:71], v94 offset:16384
    ds_read_b128 v[72:75], v94 offset:17408
    s_cmp_lg_u32 s57, 6
    s_cbranch_scc1 k2_attn_kernel_p0_nostage
    s_add_u32 s59, s50, 2
    s_lshr_b32 s56, s59, 3
    s_and_b32 s56, s56, 1
    s_lshl_b32 s56, s56, 16
    s_and_b32 s58, s59, 7
    s_lshl_b32 s58, s58, 11
    s_add_u32 s58, s58, s56
    v_add_u32 v94, s58, v117
    s_waitcnt vmcnt(0)
    ds_write_b128 v94, v[100:103]
    ds_write_b128 v94, v[104:107] offset:8192
    ds_write_b128 v94, v[108:111] offset:16384
    ds_write_b128 v94, v[112:115] offset:24576
    buffer_load_dwordx4 v[100:103], v116, s[12:15], s48 offen
    buffer_load_dwordx4 v[104:107], v118, s[12:15], s48 offen
    buffer_load_dwordx4 v[108:111], v116, s[16:19], s48 offen
    buffer_load_dwordx4 v[112:115], v118, s[16:19], s48 offen
    s_add_u32 s48, s48, 16384
    s_waitcnt lgkmcnt(0)
    s_barrier
k2_attn_kernel_p0_nostage:
    s_add_u32 s59, s50, 1
    s_lshr_b32 s56, s59, 3
    s_and_b32 s56, s56, 1
    s_lshl_b32 s56, s56, 16
    s_and_b32 s58, s59, 7
    s_lshl_b32 s58, s58, 11
    s_add_u32 s58, s58, s56
    v_add_u32 v94, s58, v97
    ds_read_b128 v[120:123], v94
    ds_read_b128 v[124:127], v94 offset:1024
    v_max3_f32 v98, v16, v17, v18
    v_max3_f32 v99, v19, v20, v21
    v_max3_f32 v92, v22, v23, v24
    v_max3_f32 v93, v25, v26, v27
    v_max3_f32 v119, v28, v29, v30
    v_max3_f32 v98, v98, v99, v31
    v_max3_f32 v98, v98, v92, v93
    v_max_f32 v98, v98, v119
    v_cmp_gt_f32 vcc, v98, v96
    s_add_u32 s50, s50, 1
    s_cbranch_vccnz k2_attn_kernel_p0_rare
k2_attn_kernel_p0_back:
    s_waitcnt lgkmcnt(0)
    v_mfma_f32_32x32x16_bf16 v[76:91], v[120:123], v[8:11], v[32:47]
    v_mfma_f32_32x32x16_bf16 v[76:91], v[124:127], v[12:15], v[76:91]
    v_exp_f32 v16, v16
    v_exp_f32 v17, v17
    v_exp_f32 v18, v18
    v_exp_f32 v19, v19
    v_exp_f32 v20, v20
    v_exp_f32 v21, v21
    v_exp_f32 v22, v22
    v_exp_f32 v23, v23
    v_exp_f32 v24, v24
    v_exp_f32 v25, v25
    v_exp_f32 v26, v26
    v_exp_f32 v27, v27
    v_exp_f32 v28, v28
    v_exp_f32 v29, v29
    v_exp_f32 v30, v30
    v_exp_f32 v31, v31
    v_cvt_pk_bf16_f32 v16, v16, v17
    v_cvt_pk_bf16_f32 v17, v18, v19
    v_cvt_pk_bf16_f32 v18, v20, v21
    v_cvt_pk_bf16_f32 v19, v22, v23
    v_cvt_pk_bf16_f32 v20, v24, v25
    v_cvt_pk_bf16_f32 v21, v26, v27
    v_cvt_pk_bf16_f32 v22, v28, v29
    v_cvt_pk_bf16_f32 v23, v30, v31
    s_nop 1
    v_mfma_f32_32x32x16_bf16 v[48:63], v[68:71], v[16:19], v[48:63]
    v_mfma_f32_32x32x16_bf16 v[48:63], v[72:75], v[20:23], v[48:63]
    s_lshr_b32 s56, s50, 3
    s_and_b32 s56, s56, 1
    s_lshl_b32 s56, s56, 16
    s_and_b32 s58, s50, 7
    s_lshl_b32 s58, s58, 11
    s_add_u32 s58, s58, s56
    v_add_u32 v94, s58, v97
    ds_read_b128 v[68:71], v94 offset:16384
    ds_read_b128 v[72:75], v94 offset:17408
    s_add_u32 s59, s50, 1
    s_lshr_b32 s56, s59, 3
    s_and_b32 s56, s56, 1
    s_lshl_b32 s56, s56, 16
    s_and_b32 s58, s59, 7
    s_lshl_b32 s58, s58, 11
    s_add_u32 s58, s58, s56
    v_add_u32 v94, s58, v97
    ds_read_b128 v[120:123], v94
    ds_read_b128 v[124:127], v94 offset:1024
    v_max3_f32 v98, v76, v77, v78
    v_max3_f32 v99, v79, v80, v81
    v_max3_f32 v92, v82, v83, v84
    v_max3_f32 v93, v85, v86, v87
    v_max3_f32 v119, v88, v89, v90
    v_max3_f32 v98, v98, v99, v91
    v_max3_f32 v98, v98, v92, v93
    v_max_f32 v98, v98, v119
    v_cmp_gt_f32 vcc, v98, v96
    s_add_u32 s50, s50, 1
    s_cbranch_vccnz k2_attn_kernel_p1_rare
k2_attn_kernel_p1_back:
    s_waitcnt lgkmcnt(0)
    v_mfma_f32_32x32x16_bf16 v[16:31], v[120:123], v[8:11], v[32:47]
    v_mfma_f32_32x32x16_bf16 v[16:31], v[124:127], v[12:15], v[16:31]
    v_exp_f32 v76, v76
    v_exp_f32 v77, v77
    v_exp_f32 v78, v78
    v_exp_f32 v79, v79
    v_exp_f32 v80, v80
    v_exp_f32 v81, v81
    v_exp_f32 v82, v82
    v_exp_f32 v83, v83
    v_exp_f32 v84, v84
    v_exp_f32 v85, v85
    v_exp_f32 v86, v86
    v_exp_f32 v87, v87
    v_exp_f32 v88, v88
    v_exp_f32 v89, v89
    v_exp_f32 v90, v90
    v_exp_f32 v91, v91
    v_cvt_pk_bf16_f32 v76, v76, v77
    v_cvt_pk_bf16_f32 v77, v78, v79
    v_cvt_pk_bf16_f32 v78, v80, v81
    v_cvt_pk_bf16_f32 v79, v82, v83
    v_cvt_pk_bf16_f32 v80, v84, v85
    v_cvt_pk_bf16_f32 v81, v86, v87
    v_cvt_pk_bf16_f32 v82, v88, v89
    v_cvt_pk_bf16_f32 v83, v90, v91
    s_nop 1
    v_mfma_f32_32x32x16_bf16 v[48:63], v[68:71], v[76:79], v[48:63]
    v_mfma_f32_32x32x16_bf16 v[48:63], v[72:75], v[80:83], v[48:63]
    s_cmp_lt_u32 s50, 32
    s_cbranch_scc1 k2_attn_kernel_loop
    s_branch k2_attn_kernel_fin
k2_attn_kernel_p0_rare:
    v_mov_b32 v99, v98
    s_nop 1
    v_permlane32_swap_b32 v98, v99
    s_nop 1
    v_max3_f32 v98, v98, v99, v95
    v_sub_f32 v99, 0, v98
    v_exp_f32 v99, v99
    s_nop 7
    v_sub_f32 v16, v16, v98
    v_sub_f32 v32, v32, v98
    v_mul_f32 v48, v48, v99
    v_sub_f32 v17, v17, v98
    v_sub_f32 v33, v33, v98
    v_mul_f32 v49, v49, v99
    v_sub_f32 v18, v18, v98
    v_sub_f32 v34, v34, v98
    v_mul_f32 v50, v50, v99
    v_sub_f32 v19, v19, v98
    v_sub_f32 v35, v35, v98
    v_mul_f32 v51, v51, v99
    v_sub_f32 v20, v20, v98
    v_sub_f32 v36, v36, v98
    v_mul_f32 v52, v52, v99
    v_sub_f32 v21, v21, v98
    v_sub_f32 v37, v37, v98
    v_mul_f32 v53, v53, v99
    v_sub_f32 v22, v22, v98
    v_sub_f32 v38, v38, v98
    v_mul_f32 v54, v54, v99
    v_sub_f32 v23, v23, v98
    v_sub_f32 v39, v39, v98
    v_mul_f32 v55, v55, v99
    v_sub_f32 v24, v24, v98
    v_sub_f32 v40, v40, v98
    v_mul_f32 v56, v56, v99
    v_sub_f32 v25, v25, v98
    v_sub_f32 v41, v41, v98
    v_mul_f32 v57, v57, v99
    v_sub_f32 v26, v26, v98
    v_sub_f32 v42, v42, v98
    v_mul_f32 v58, v58, v99
    v_sub_f32 v27, v27, v98
    v_sub_f32 v43, v43, v98
    v_mul_f32 v59, v59, v99
    v_sub_f32 v28, v28, v98
    v_sub_f32 v44, v44, v98
    v_mul_f32 v60, v60, v99
    v_sub_f32 v29, v29, v98
    v_sub_f32 v45, v45, v98
    v_mul_f32 v61, v61, v99
    v_sub_f32 v30, v30, v98
    v_sub_f32 v46, v46, v98
    v_mul_f32 v62, v62, v99
    v_sub_f32 v31, v31, v98
    v_sub_f32 v47, v47, v98
    v_mul_f32 v63, v63, v99
    v_mov_b32 v96, 0x41000000
    v_mov_b32 v95, 0
    s_nop 1
    s_branch k2_attn_kernel_p0_back
k2_attn_kernel_p1_rare:
    v_mov_b32 v99, v98
    s_nop 1
    v_permlane32_swap_b32 v98, v99
    s_nop 1
    v_max3_f32 v98, v98, v99, v95
    v_sub_f32 v99, 0, v98
    v_exp_f32 v99, v99
    s_nop 7
    v_sub_f32 v76, v76, v98
    v_sub_f32 v32, v32, v98
    v_mul_f32 v48, v48, v99
    v_sub_f32 v77, v77, v98
    v_sub_f32 v33, v33, v98
    v_mul_f32 v49, v49, v99
    v_sub_f32 v78, v78, v98
    v_sub_f32 v34, v34, v98
    v_mul_f32 v50, v50, v99
    v_sub_f32 v79, v79, v98
    v_sub_f32 v35, v35, v98
    v_mul_f32 v51, v51, v99
    v_sub_f32 v80, v80, v98
    v_sub_f32 v36, v36, v98
    v_mul_f32 v52, v52, v99
    v_sub_f32 v81, v81, v98
    v_sub_f32 v37, v37, v98
    v_mul_f32 v53, v53, v99
    v_sub_f32 v82, v82, v98
    v_sub_f32 v38, v38, v98
    v_mul_f32 v54, v54, v99
    v_sub_f32 v83, v83, v98
    v_sub_f32 v39, v39, v98
    v_mul_f32 v55, v55, v99
    v_sub_f32 v84, v84, v98
    v_sub_f32 v40, v40, v98
    v_mul_f32 v56, v56, v99
    v_sub_f32 v85, v85, v98
    v_sub_f32 v41, v41, v98
    v_mul_f32 v57, v57, v99
    v_sub_f32 v86, v86, v98
    v_sub_f32 v42, v42, v98
    v_mul_f32 v58, v58, v99
    v_sub_f32 v87, v87, v98
    v_sub_f32 v43, v43, v98
    v_mul_f32 v59, v59, v99
    v_sub_f32 v88, v88, v98
    v_sub_f32 v44, v44, v98
    v_mul_f32 v60, v60, v99
    v_sub_f32 v89, v89, v98
    v_sub_f32 v45, v45, v98
    v_mul_f32 v61, v61, v99
    v_sub_f32 v90, v90, v98
    v_sub_f32 v46, v46, v98
    v_mul_f32 v62, v62, v99
    v_sub_f32 v91, v91, v98
    v_sub_f32 v47, v47, v98
    v_mul_f32 v63, v63, v99
    v_mov_b32 v96, 0x41000000
    v_mov_b32 v95, 0
    s_nop 1
    s_branch k2_attn_kernel_p1_back
k2_attn_kernel_fin:
    s_waitcnt vmcnt(0) lgkmcnt(0)
    s_nop 15
    s_barrier
    s_and_b32 s44, s42, 7
    s_mul_i32 s44, s44, 4352
    v_lshlrev_b32 v94, 2, v2
    v_add_u32 v94, s44, v94
    s_cmp_eq_u32 s43, 0
    s_cbranch_scc1 k2_attn_kernel_h0
    ds_write_b32 v94, v32
    ds_write_b32 v94, v48 offset:256
    ds_write_b32 v94, v49 offset:512
    ds_write_b32 v94, v50 offset:768
    ds_write_b32 v94, v51 offset:1024
    ds_write_b32 v94, v52 offset:1280
    ds_write_b32 v94, v53 offset:1536
    ds_write_b32 v94, v54 offset:1792
    ds_write_b32 v94, v55 offset:2048
    ds_write_b32 v94, v56 offset:2304
    ds_write_b32 v94, v57 offset:2560
    ds_write_b32 v94, v58 offset:2816
    ds_write_b32 v94, v59 offset:3072
    ds_write_b32 v94, v60 offset:3328
    ds_write_b32 v94, v61 offset:3584
    ds_write_b32 v94, v62 offset:3840
    ds_write_b32 v94, v63 offset:4096
    s_waitcnt lgkmcnt(0)
    s_barrier
    s_endpgm
k2_attn_kernel_h0:
    s_barrier
    ds_read_b32 v98, v94
    ds_read_b32 v16, v94 offset:256
    ds_read_b32 v17, v94 offset:512
    ds_read_b32 v18, v94 offset:768
    ds_read_b32 v19, v94 offset:1024
    ds_read_b32 v20, v94 offset:1280
    ds_read_b32 v21, v94 offset:1536
    ds_read_b32 v22, v94 offset:1792
    ds_read_b32 v23, v94 offset:2048
    ds_read_b32 v24, v94 offset:2304
    ds_read_b32 v25, v94 offset:2560
    ds_read_b32 v26, v94 offset:2816
    ds_read_b32 v27, v94 offset:3072
    ds_read_b32 v28, v94 offset:3328
    ds_read_b32 v29, v94 offset:3584
    ds_read_b32 v30, v94 offset:3840
    ds_read_b32 v31, v94 offset:4096
    s_waitcnt lgkmcnt(0)
    v_min_f32 v99, v98, v32
    v_sub_f32 v92, v99, v32
    v_sub_f32 v93, v99, v98
    v_exp_f32 v92, v92
    v_exp_f32 v93, v93
    s_nop 0
    v_mul_f32 v48, v48, v92
    v_fmac_f32 v48, v16, v93
    v_mul_f32 v49, v49, v92
    v_fmac_f32 v49, v17, v93
    v_mul_f32 v50, v50, v92
    v_fmac_f32 v50, v18, v93
    v_mul_f32 v51, v51, v92
    v_fmac_f32 v51, v19, v93
    v_mul_f32 v52, v52, v92
    v_fmac_f32 v52, v20, v93
    v_mul_f32 v53, v53, v92
    v_fmac_f32 v53, v21, v93
    v_mul_f32 v54, v54, v92
    v_fmac_f32 v54, v22, v93
    v_mul_f32 v55, v55, v92
    v_fmac_f32 v55, v23, v93
    v_mul_f32 v56, v56, v92
    v_fmac_f32 v56, v24, v93
    v_mul_f32 v57, v57, v92
    v_fmac_f32 v57, v25, v93
    v_mul_f32 v58, v58, v92
    v_fmac_f32 v58, v26, v93
    v_mul_f32 v59, v59, v92
    v_fmac_f32 v59, v27, v93
    v_mul_f32 v60, v60, v92
    v_fmac_f32 v60, v28, v93
    v_mul_f32 v61, v61, v92
    v_fmac_f32 v61, v29, v93
    v_mul_f32 v62, v62, v92
    v_fmac_f32 v62, v30, v93
    v_mul_f32 v63, v63, v92
    v_fmac_f32 v63, v31, v93
    v_mov_b32 v98, v56
    v_mov_b32 v99, v56
    s_nop 1
    v_permlane32_swap_b32 v98, v99
    s_nop 1
    v_rcp_f32 v99, v99
    s_nop 0
    v_mul_f32 v48, v48, v99
    v_mul_f32 v49, v49, v99
    v_mul_f32 v50, v50, v99
    v_mul_f32 v51, v51, v99
    v_mul_f32 v52, v52, v99
    v_mul_f32 v53, v53, v99
    v_mul_f32 v54, v54, v99
    v_mul_f32 v55, v55, v99
    v_mul_f32 v56, v56, v99
    v_mul_f32 v57, v57, v99
    v_mul_f32 v58, v58, v99
    v_mul_f32 v59, v59, v99
    v_cvt_pk_bf16_f32 v64, v48, v49
    v_cvt_pk_bf16_f32 v65, v50, v51
    v_cvt_pk_bf16_f32 v66, v52, v53
    v_cvt_pk_bf16_f32 v67, v54, v55
    v_cvt_pk_bf16_f32 v68, v56, v57
    v_cvt_pk_bf16_f32 v69, v58, v59
    v_lshl_add_u32 v7, v5, 3, v6
    buffer_store_dwordx2 v[64:65], v7, s[20:23], 0 offen
    buffer_store_dwordx2 v[66:67], v7, s[20:23], 0 offen offset:16
    v_cmp_gt_u32 vcc, 32, v2
    s_and_saveexec_b64 s[50:51], vcc
    buffer_store_dwordx2 v[68:69], v7, s[20:23], 0 offen offset:32
k2_attn_kernel_end:
    s_endpgm
.globl k3_wo_kernel
.p2align 8
.type k3_wo_kernel,@function
k3_wo_kernel:
    s_cmp_ge_u32 s2, 256
    s_cbranch_scc1 k3_wo_kernel_end
    s_load_dwordx2 s[4:5], s[0:1], 96
    s_load_dwordx2 s[6:7], s[0:1], 32
    s_load_dwordx2 s[36:37], s[0:1], 0
    s_mul_hi_u32 s32, s2, 536870913
    s_mul_i32 s33, s32, 8
    s_sub_u32 s33, s2, s33
    s_lshl_b32 s40, s32, 6
    s_mul_i32 s41, s33, 80
    v_lshrrev_b32 v1, 6, v0
    v_and_b32 v2, 63, v0
    v_readfirstlane_b32 s42, v1
    v_lshrrev_b32 v8, 3, v2
    v_and_b32 v9, 7, v2
    v_xor_b32 v9, v9, v8
    s_lshl_b32 s43, s42, 4
    s_add_u32 s43, s43, s40
    v_add_u32 v10, s43, v8
    s_mov_b32 s45, 1280
    v_mul_lo_u32 v10, v10, s45
    v_lshl_add_u32 v10, v9, 4, v10
    v_add_u32 v11, 10240, v10
    s_mov_b32 s46, 1280
    s_mov_b32 s48, 429496730
    s_lshl_b32 s47, s41, 1
    s_mul_i32 s44, s42, 192
    v_add_u32 v50, s44, v2
    v_mul_hi_u32 v51, v50, s48
    v_mul_u32_u24 v52, 10, v51
    v_sub_u32 v52, v50, v52
    v_mul_lo_u32 v53, v51, s46
    v_lshl_add_u32 v53, v52, 4, v53
    v_add_u32 v240, s47, v53
    v_mov_b32 v53, 0x7ffffff0
    v_cmp_le_u32 vcc, 640, v50
    s_nop 1
    v_cndmask_b32 v240, v240, v53, vcc
    v_add_u32 v50, s44, v2
    v_add_u32 v50, 64, v50
    v_mul_hi_u32 v51, v50, s48
    v_mul_u32_u24 v52, 10, v51
    v_sub_u32 v52, v50, v52
    v_mul_lo_u32 v53, v51, s46
    v_lshl_add_u32 v53, v52, 4, v53
    v_add_u32 v241, s47, v53
    v_mov_b32 v53, 0x7ffffff0
    v_cmp_le_u32 vcc, 640, v50
    s_nop 1
    v_cndmask_b32 v241, v241, v53, vcc
    v_add_u32 v50, s44, v2
    v_add_u32 v50, 128, v50
    v_mul_hi_u32 v51, v50, s48
    v_mul_u32_u24 v52, 10, v51
    v_sub_u32 v52, v50, v52
    v_mul_lo_u32 v53, v51, s46
    v_lshl_add_u32 v53, v52, 4, v53
    v_add_u32 v242, s47, v53
    v_mov_b32 v53, 0x7ffffff0
    v_cmp_le_u32 vcc, 640, v50
    s_nop 1
    v_cndmask_b32 v242, v242, v53, vcc
    s_waitcnt lgkmcnt(0)
    s_add_u32 s8, s4, 4194304
    s_addc_u32 s9, s5, 0
    s_and_b32 s9, s9, 0xffff
    s_mov_b32 s10, 2621440
    s_mov_b32 s11, 0x00020000
    s_mov_b32 s12, s6
    s_mov_b32 s13, s7
    s_and_b32 s13, s13, 0xffff
    s_mov_b32 s14, 819200
    s_mov_b32 s15, 0x00020000
    s_mov_b32 s49, 0
    s_mov_b32 s50, 0
    s_mov_b32 s60, 0
    s_mov_b32 s62, 0
    s_mov_b32 s63, 0
    s_lshl_b32 s64, s42, 11
    s_mul_i32 s65, s42, 3072
    s_add_u32 s65, s65, 8192
    s_lshr_b32 s53, s42, 0
    s_and_b32 s54, s42, 0
    v_and_b32 v3, 15, v2
    v_lshrrev_b32 v4, 4, v2
    s_mul_i32 s55, s53, 16
    s_add_u32 s55, s55, s40
    v_add_u32 v5, s55, v3
    s_mul_i32 s56, s54, 80
    s_add_u32 s56, s56, s41
    v_lshl_add_u32 v6, v4, 2, s56
    s_mov_b32 s44, 1280
    v_mul_lo_u32 v7, v5, s44
    v_lshl_add_u32 v7, v6, 1, v7
    v_add_u32 v16, 20480, v7
    s_mov_b32 s20, s36
    s_mov_b32 s21, s37
    s_and_b32 s21, s21, 0xffff
    s_mov_b32 s22, 2621440
    s_mov_b32 s23, 0x00020000
    buffer_load_dwordx2 v[140:141], v7, s[20:23], 0 offen offset:0
    buffer_load_dwordx2 v[142:143], v7, s[20:23], 0 offen offset:32
    buffer_load_dwordx2 v[144:145], v7, s[20:23], 0 offen offset:64
    buffer_load_dwordx2 v[146:147], v7, s[20:23], 0 offen offset:96
    buffer_load_dwordx2 v[148:149], v7, s[20:23], 0 offen offset:128
    s_cmp_lt_u32 s60, 10
    s_cselect_b32 s61, s62, 0x7ffffff0
    s_add_u32 s60, s60, 1
    s_add_u32 s62, s62, 128
    s_add_u32 m0, s63, s64
    s_nop 0
    buffer_load_dwordx4 v10, s[8:11], s61 offen lds
    s_add_u32 m0, m0, 1024
    s_nop 0
    buffer_load_dwordx4 v11, s[8:11], s61 offen lds
    s_add_u32 m0, s63, s65
    s_nop 0
    buffer_load_dwordx4 v240, s[12:15], s49 offen lds
    s_add_u32 m0, m0, 1024
    s_nop 0
    buffer_load_dwordx4 v241, s[12:15], s49 offen lds
    s_add_u32 m0, m0, 1024
    s_nop 0
    buffer_load_dwordx4 v242, s[12:15], s49 offen lds
    s_add_u32 s49, s49, 81920
    s_add_u32 s63, s63, 20480
    s_cmp_eq_u32 s63, 122880
    s_cselect_b32 s63, 0, s63
    s_cmp_lt_u32 s60, 10
    s_cselect_b32 s61, s62, 0x7ffffff0
    s_add_u32 s60, s60, 1
    s_add_u32 s62, s62, 128
    s_add_u32 m0, s63, s64
    s_nop 0
    buffer_load_dwordx4 v10, s[8:11], s61 offen lds
    s_add_u32 m0, m0, 1024
    s_nop 0
    buffer_load_dwordx4 v11, s[8:11], s61 offen lds
    s_add_u32 m0, s63, s65
    s_nop 0
    buffer_load_dwordx4 v240, s[12:15], s49 offen lds
    s_add_u32 m0, m0, 1024
    s_nop 0
    buffer_load_dwordx4 v241, s[12:15], s49 offen lds
    s_add_u32 m0, m0, 1024
    s_nop 0
    buffer_load_dwordx4 v242, s[12:15], s49 offen lds
    s_add_u32 s49, s49, 81920
    s_add_u32 s63, s63, 20480
    s_cmp_eq_u32 s63, 122880
    s_cselect_b32 s63, 0, s63
    s_cmp_lt_u32 s60, 10
    s_cselect_b32 s61, s62, 0x7ffffff0
    s_add_u32 s60, s60, 1
    s_add_u32 s62, s62, 128
    s_add_u32 m0, s63, s64
    s_nop 0
    buffer_load_dwordx4 v10, s[8:11], s61 offen lds
    s_add_u32 m0, m0, 1024
    s_nop 0
    buffer_load_dwordx4 v11, s[8:11], s61 offen lds
    s_add_u32 m0, s63, s65
    s_nop 0
    buffer_load_dwordx4 v240, s[12:15], s49 offen lds
    s_add_u32 m0, m0, 1024
    s_nop 0
    buffer_load_dwordx4 v241, s[12:15], s49 offen lds
    s_add_u32 m0, m0, 1024
    s_nop 0
    buffer_load_dwordx4 v242, s[12:15], s49 offen lds
    s_add_u32 s49, s49, 81920
    s_add_u32 s63, s63, 20480
    s_cmp_eq_u32 s63, 122880
    s_cselect_b32 s63, 0, s63
    s_cmp_lt_u32 s60, 10
    s_cselect_b32 s61, s62, 0x7ffffff0
    s_add_u32 s60, s60, 1
    s_add_u32 s62, s62, 128
    s_add_u32 m0, s63, s64
    s_nop 0
    buffer_load_dwordx4 v10, s[8:11], s61 offen lds
    s_add_u32 m0, m0, 1024
    s_nop 0
    buffer_load_dwordx4 v11, s[8:11], s61 offen lds
    s_add_u32 m0, s63, s65
    s_nop 0
    buffer_load_dwordx4 v240, s[12:15], s49 offen lds
    s_add_u32 m0, m0, 1024
    s_nop 0
    buffer_load_dwordx4 v241, s[12:15], s49 offen lds
    s_add_u32 m0, m0, 1024
    s_nop 0
    buffer_load_dwordx4 v242, s[12:15], s49 offen lds
    s_add_u32 s49, s49, 81920
    s_add_u32 s63, s63, 20480
    s_cmp_eq_u32 s63, 122880
    s_cselect_b32 s63, 0, s63
    s_cmp_lt_u32 s60, 10
    s_cselect_b32 s61, s62, 0x7ffffff0
    s_add_u32 s60, s60, 1
    s_add_u32 s62, s62, 128
    s_add_u32 m0, s63, s64
    s_nop 0
    buffer_load_dwordx4 v10, s[8:11], s61 offen lds
    s_add_u32 m0, m0, 1024
    s_nop 0
    buffer_load_dwordx4 v11, s[8:11], s61 offen lds
    s_add_u32 m0, s63, s65
    s_nop 0
    buffer_load_dwordx4 v240, s[12:15], s49 offen lds
    s_add_u32 m0, m0, 1024
    s_nop 0
    buffer_load_dwordx4 v241, s[12:15], s49 offen lds
    s_add_u32 m0, m0, 1024
    s_nop 0
    buffer_load_dwordx4 v242, s[12:15], s49 offen lds
    s_add_u32 s49, s49, 81920
    s_add_u32 s63, s63, 20480
    s_cmp_eq_u32 s63, 122880
    s_cselect_b32 s63, 0, s63
    s_lshr_b32 s53, s42, 0
    s_and_b32 s54, s42, 0
    v_and_b32 v3, 15, v2
    v_lshrrev_b32 v4, 4, v2
    v_and_b32 v22, 7, v3
    v_xor_b32 v22, v22, v4
    v_lshlrev_b32 v22, 4, v22
    v_lshl_add_u32 v22, v3, 7, v22
    s_mul_i32 s55, s53, 2048
    v_add_u32 v22, s55, v22
    v_xor_b32 v23, 64, v22
    v_lshrrev_b32 v24, 2, v3
    v_lshl_add_u32 v24, v4, 3, v24
    v_mul_u32_u24 v24, 160, v24
    v_and_b32 v25, 3, v2
    v_lshl_add_u32 v24, v25, 3, v24
    s_mul_i32 s55, s54, 160
    s_add_u32 s55, s55, 8192
    v_add_u32 v24, s55, v24
    v_mov_b32 v72, 0
    v_mov_b32 v73, 0
    v_mov_b32 v74, 0
    v_mov_b32 v75, 0
    v_mov_b32 v76, 0
    v_mov_b32 v77, 0
    v_mov_b32 v78, 0
    v_mov_b32 v79, 0
    v_mov_b32 v80, 0
    v_mov_b32 v81, 0
    v_mov_b32 v82, 0
    v_mov_b32 v83, 0
    v_mov_b32 v84, 0
    v_mov_b32 v85, 0
    v_mov_b32 v86, 0
    v_mov_b32 v87, 0
    v_mov_b32 v88, 0
    v_mov_b32 v89, 0
    v_mov_b32 v90, 0
    v_mov_b32 v91, 0
    v_mov_b32 v60, 0
    v_mov_b32 v62, 0
    v_mov_b32 v64, 0x3f803f80
    s_mov_b32 s66, 0
    s_mov_b32 s51, 10
k3_wo_kernel_loop:
    s_waitcnt vmcnt(20)
    s_barrier
    v_add_u32 v26, s66, v22
    v_add_u32 v27, s66, v23
    v_add_u32 v28, s66, v24
    ds_read_b128 v[92:95], v26 offset:0
    ds_read_b64_tr_b16 v[96:97], v28 offset:0
    ds_read_b64_tr_b16 v[98:99], v28 offset:640
    ds_read_b64_tr_b16 v[100:101], v28 offset:32
    ds_read_b64_tr_b16 v[102:103], v28 offset:672
    ds_read_b64_tr_b16 v[104:105], v28 offset:64
    ds_read_b64_tr_b16 v[106:107], v28 offset:704
    ds_read_b64_tr_b16 v[108:109], v28 offset:96
    ds_read_b64_tr_b16 v[110:111], v28 offset:736
    ds_read_b64_tr_b16 v[112:113], v28 offset:128
    ds_read_b64_tr_b16 v[114:115], v28 offset:768
    ds_read_b128 v[116:119], v27 offset:0
    ds_read_b64_tr_b16 v[120:121], v28 offset:5120
    ds_read_b64_tr_b16 v[122:123], v28 offset:5760
    ds_read_b64_tr_b16 v[124:125], v28 offset:5152
    ds_read_b64_tr_b16 v[126:127], v28 offset:5792
    ds_read_b64_tr_b16 v[128:129], v28 offset:5184
    ds_read_b64_tr_b16 v[130:131], v28 offset:5824
    ds_read_b64_tr_b16 v[132:133], v28 offset:5216
    ds_read_b64_tr_b16 v[134:135], v28 offset:5856
    ds_read_b64_tr_b16 v[136:137], v28 offset:5248
    ds_read_b64_tr_b16 v[138:139], v28 offset:5888
    s_cmp_lt_u32 s60, 10
    s_cselect_b32 s61, s62, 0x7ffffff0
    s_add_u32 s60, s60, 1
    s_add_u32 s62, s62, 128
    s_add_u32 m0, s63, s64
    s_nop 0
    buffer_load_dwordx4 v10, s[8:11], s61 offen lds
    s_add_u32 m0, m0, 1024
    s_nop 0
    buffer_load_dwordx4 v11, s[8:11], s61 offen lds
    s_add_u32 m0, s63, s65
    s_nop 0
    buffer_load_dwordx4 v240, s[12:15], s49 offen lds
    s_add_u32 m0, m0, 1024
    s_nop 0
    buffer_load_dwordx4 v241, s[12:15], s49 offen lds
    s_add_u32 m0, m0, 1024
    s_nop 0
    buffer_load_dwordx4 v242, s[12:15], s49 offen lds
    s_add_u32 s49, s49, 81920
    s_add_u32 s63, s63, 20480
    s_cmp_eq_u32 s63, 122880
    s_cselect_b32 s63, 0, s63
    s_waitcnt lgkmcnt(11)
    v_mfma_f32_16x16x32_bf16 v[72:75], v[96:99], v[92:95], v[72:75]
    v_mfma_f32_16x16x32_bf16 v[76:79], v[100:103], v[92:95], v[76:79]
    v_mfma_f32_16x16x32_bf16 v[80:83], v[104:107], v[92:95], v[80:83]
    v_mfma_f32_16x16x32_bf16 v[84:87], v[108:111], v[92:95], v[84:87]
    v_mfma_f32_16x16x32_bf16 v[88:91], v[112:115], v[92:95], v[88:91]
    s_waitcnt lgkmcnt(0)
    v_mfma_f32_16x16x32_bf16 v[72:75], v[120:123], v[116:119], v[72:75]
    v_mfma_f32_16x16x32_bf16 v[76:79], v[124:127], v[116:119], v[76:79]
    v_mfma_f32_16x16x32_bf16 v[80:83], v[128:131], v[116:119], v[80:83]
    v_mfma_f32_16x16x32_bf16 v[84:87], v[132:135], v[116:119], v[84:87]
    v_mfma_f32_16x16x32_bf16 v[88:91], v[136:139], v[116:119], v[88:91]
    s_add_u32 s66, s66, 20480
    s_cmp_eq_u32 s66, 122880
    s_cselect_b32 s66, 0, s66
    s_sub_u32 s51, s51, 1
    s_cmp_lg_u32 s51, 0
    s_cbranch_scc1 k3_wo_kernel_loop
    s_waitcnt vmcnt(0)
    s_barrier
    s_nop 7
    s_waitcnt vmcnt(0)
    s_add_u32 s16, s4, 7340032
    s_addc_u32 s17, s5, 0
    s_and_b32 s17, s17, 0xffff
    s_mov_b32 s18, 2621440
    s_mov_b32 s19, 0x00020000
    v_lshlrev_b32 v50, 16, v140
    v_and_b32 v51, 0xffff0000, v140
    v_add_f32 v72, v72, v50
    v_add_f32 v73, v73, v51
    v_lshlrev_b32 v50, 16, v141
    v_and_b32 v51, 0xffff0000, v141
    v_add_f32 v74, v74, v50
    v_add_f32 v75, v75, v51
    v_lshlrev_b32 v50, 16, v142
    v_and_b32 v51, 0xffff0000, v142
    v_add_f32 v76, v76, v50
    v_add_f32 v77, v77, v51
    v_lshlrev_b32 v50, 16, v143
    v_and_b32 v51, 0xffff0000, v143
    v_add_f32 v78, v78, v50
    v_add_f32 v79, v79, v51
    v_lshlrev_b32 v50, 16, v144
    v_and_b32 v51, 0xffff0000, v144
    v_add_f32 v80, v80, v50
    v_add_f32 v81, v81, v51
    v_lshlrev_b32 v50, 16, v145
    v_and_b32 v51, 0xffff0000, v145
    v_add_f32 v82, v82, v50
    v_add_f32 v83, v83, v51
    v_lshlrev_b32 v50, 16, v146
    v_and_b32 v51, 0xffff0000, v146
    v_add_f32 v84, v84, v50
    v_add_f32 v85, v85, v51
    v_lshlrev_b32 v50, 16, v147
    v_and_b32 v51, 0xffff0000, v147
    v_add_f32 v86, v86, v50
    v_add_f32 v87, v87, v51
    v_lshlrev_b32 v50, 16, v148
    v_and_b32 v51, 0xffff0000, v148
    v_add_f32 v88, v88, v50
    v_add_f32 v89, v89, v51
    v_lshlrev_b32 v50, 16, v149
    v_and_b32 v51, 0xffff0000, v149
    v_add_f32 v90, v90, v50
    v_add_f32 v91, v91, v51
    v_cvt_pk_bf16_f32 v50, v72, v73
    v_cvt_pk_bf16_f32 v51, v74, v75
    buffer_store_dwordx2 v[50:51], v7, s[16:19], 0 offen offset:0
    v_cvt_pk_bf16_f32 v50, v76, v77
    v_cvt_pk_bf16_f32 v51, v78, v79
    buffer_store_dwordx2 v[50:51], v7, s[16:19], 0 offen offset:32
    v_cvt_pk_bf16_f32 v50, v80, v81
    v_cvt_pk_bf16_f32 v51, v82, v83
    buffer_store_dwordx2 v[50:51], v7, s[16:19], 0 offen offset:64
    v_cvt_pk_bf16_f32 v50, v84, v85
    v_cvt_pk_bf16_f32 v51, v86, v87
    buffer_store_dwordx2 v[50:51], v7, s[16:19], 0 offen offset:96
    v_cvt_pk_bf16_f32 v50, v88, v89
    v_cvt_pk_bf16_f32 v51, v90, v91
    buffer_store_dwordx2 v[50:51], v7, s[16:19], 0 offen offset:128
    s_waitcnt vmcnt(0)
    s_branch k3_wo_kernel_end
k3_wo_kernel_end:
    s_endpgm
.globl k4_w1_kernel
.p2align 8
.type k4_w1_kernel,@function
k4_w1_kernel:
    s_cmp_ge_u32 s2, 256
    s_cbranch_scc1 k4_w1_kernel_end
    s_load_dwordx2 s[4:5], s[0:1], 96
    s_load_dwordx2 s[6:7], s[0:1], 48
    s_mul_hi_u32 s32, s2, 536870913
    s_mul_i32 s33, s32, 8
    s_sub_u32 s33, s2, s33
    s_lshl_b32 s40, s32, 6
    s_mul_i32 s41, s33, 80
    v_lshrrev_b32 v1, 6, v0
    v_and_b32 v2, 63, v0
    v_readfirstlane_b32 s42, v1
    v_lshrrev_b32 v8, 3, v2
    v_and_b32 v9, 7, v2
    v_xor_b32 v9, v9, v8
    s_lshl_b32 s43, s42, 4
    s_add_u32 s43, s43, s40
    v_add_u32 v10, s43, v8
    s_mov_b32 s45, 1280
    v_mul_lo_u32 v10, v10, s45
    v_lshl_add_u32 v10, v9, 4, v10
    v_add_u32 v11, 10240, v10
    s_mov_b32 s46, 1280
    s_mov_b32 s48, 429496730
    s_lshl_b32 s47, s41, 1
    s_mul_i32 s44, s42, 192
    v_add_u32 v50, s44, v2
    v_mul_hi_u32 v51, v50, s48
    v_mul_u32_u24 v52, 10, v51
    v_sub_u32 v52, v50, v52
    v_mul_lo_u32 v53, v51, s46
    v_lshl_add_u32 v53, v52, 4, v53
    v_add_u32 v240, s47, v53
    v_mov_b32 v53, 0x7ffffff0
    v_cmp_le_u32 vcc, 640, v50
    s_nop 1
    v_cndmask_b32 v240, v240, v53, vcc
    v_add_u32 v50, s44, v2
    v_add_u32 v50, 64, v50
    v_mul_hi_u32 v51, v50, s48
    v_mul_u32_u24 v52, 10, v51
    v_sub_u32 v52, v50, v52
    v_mul_lo_u32 v53, v51, s46
    v_lshl_add_u32 v53, v52, 4, v53
    v_add_u32 v241, s47, v53
    v_mov_b32 v53, 0x7ffffff0
    v_cmp_le_u32 vcc, 640, v50
    s_nop 1
    v_cndmask_b32 v241, v241, v53, vcc
    v_add_u32 v50, s44, v2
    v_add_u32 v50, 128, v50
    v_mul_hi_u32 v51, v50, s48
    v_mul_u32_u24 v52, 10, v51
    v_sub_u32 v52, v50, v52
    v_mul_lo_u32 v53, v51, s46
    v_lshl_add_u32 v53, v52, 4, v53
    v_add_u32 v242, s47, v53
    v_mov_b32 v53, 0x7ffffff0
    v_cmp_le_u32 vcc, 640, v50
    s_nop 1
    v_cndmask_b32 v242, v242, v53, vcc
    s_waitcnt lgkmcnt(0)
    s_add_u32 s8, s4, 7340032
    s_addc_u32 s9, s5, 0
    s_and_b32 s9, s9, 0xffff
    s_mov_b32 s10, 2621440
    s_mov_b32 s11, 0x00020000
    s_mov_b32 s12, s6
    s_mov_b32 s13, s7
    s_and_b32 s13, s13, 0xffff
    s_mov_b32 s14, 819200
    s_mov_b32 s15, 0x00020000
    s_mov_b32 s49, 0
    s_mov_b32 s50, 0
    s_mov_b32 s60, 0
    s_mov_b32 s62, 0
    s_mov_b32 s63, 0
    s_lshl_b32 s64, s42, 11
    s_mul_i32 s65, s42, 3072
    s_add_u32 s65, s65, 8192
    s_lshr_b32 s53, s42, 0
    s_and_b32 s54, s42, 0
    v_and_b32 v3, 15, v2
    v_lshrrev_b32 v4, 4, v2
    s_mul_i32 s55, s53, 16
    s_add_u32 s55, s55, s40
    v_add_u32 v5, s55, v3
    s_mul_i32 s56, s54, 80
    s_add_u32 s56, s56, s41
    v_lshl_add_u32 v6, v4, 2, s56
    s_mov_b32 s44, 1280
    v_mul_lo_u32 v7, v5, s44
    v_lshl_add_u32 v7, v6, 1, v7
    v_add_u32 v16, 20480, v7
    s_cmp_lt_u32 s60, 10
    s_cselect_b32 s61, s62, 0x7ffffff0
    s_add_u32 s60, s60, 1
    s_add_u32 s62, s62, 128
    s_add_u32 m0, s63, s64
    s_nop 0
    buffer_load_dwordx4 v10, s[8:11], s61 offen lds
    s_add_u32 m0, m0, 1024
    s_nop 0
    buffer_load_dwordx4 v11, s[8:11], s61 offen lds
    s_add_u32 m0, s63, s65
    s_nop 0
    buffer_load_dwordx4 v240, s[12:15], s49 offen lds
    s_add_u32 m0, m0, 1024
    s_nop 0
    buffer_load_dwordx4 v241, s[12:15], s49 offen lds
    s_add_u32 m0, m0, 1024
    s_nop 0
    buffer_load_dwordx4 v242, s[12:15], s49 offen lds
    s_add_u32 s49, s49, 81920
    s_add_u32 s63, s63, 20480
    s_cmp_eq_u32 s63, 122880
    s_cselect_b32 s63, 0, s63
    s_cmp_lt_u32 s60, 10
    s_cselect_b32 s61, s62, 0x7ffffff0
    s_add_u32 s60, s60, 1
    s_add_u32 s62, s62, 128
    s_add_u32 m0, s63, s64
    s_nop 0
    buffer_load_dwordx4 v10, s[8:11], s61 offen lds
    s_add_u32 m0, m0, 1024
    s_nop 0
    buffer_load_dwordx4 v11, s[8:11], s61 offen lds
    s_add_u32 m0, s63, s65
    s_nop 0
    buffer_load_dwordx4 v240, s[12:15], s49 offen lds
    s_add_u32 m0, m0, 1024
    s_nop 0
    buffer_load_dwordx4 v241, s[12:15], s49 offen lds
    s_add_u32 m0, m0, 1024
    s_nop 0
    buffer_load_dwordx4 v242, s[12:15], s49 offen lds
    s_add_u32 s49, s49, 81920
    s_add_u32 s63, s63, 20480
    s_cmp_eq_u32 s63, 122880
    s_cselect_b32 s63, 0, s63
    s_cmp_lt_u32 s60, 10
    s_cselect_b32 s61, s62, 0x7ffffff0
    s_add_u32 s60, s60, 1
    s_add_u32 s62, s62, 128
    s_add_u32 m0, s63, s64
    s_nop 0
    buffer_load_dwordx4 v10, s[8:11], s61 offen lds
    s_add_u32 m0, m0, 1024
    s_nop 0
    buffer_load_dwordx4 v11, s[8:11], s61 offen lds
    s_add_u32 m0, s63, s65
    s_nop 0
    buffer_load_dwordx4 v240, s[12:15], s49 offen lds
    s_add_u32 m0, m0, 1024
    s_nop 0
    buffer_load_dwordx4 v241, s[12:15], s49 offen lds
    s_add_u32 m0, m0, 1024
    s_nop 0
    buffer_load_dwordx4 v242, s[12:15], s49 offen lds
    s_add_u32 s49, s49, 81920
    s_add_u32 s63, s63, 20480
    s_cmp_eq_u32 s63, 122880
    s_cselect_b32 s63, 0, s63
    s_cmp_lt_u32 s60, 10
    s_cselect_b32 s61, s62, 0x7ffffff0
    s_add_u32 s60, s60, 1
    s_add_u32 s62, s62, 128
    s_add_u32 m0, s63, s64
    s_nop 0
    buffer_load_dwordx4 v10, s[8:11], s61 offen lds
    s_add_u32 m0, m0, 1024
    s_nop 0
    buffer_load_dwordx4 v11, s[8:11], s61 offen lds
    s_add_u32 m0, s63, s65
    s_nop 0
    buffer_load_dwordx4 v240, s[12:15], s49 offen lds
    s_add_u32 m0, m0, 1024
    s_nop 0
    buffer_load_dwordx4 v241, s[12:15], s49 offen lds
    s_add_u32 m0, m0, 1024
    s_nop 0
    buffer_load_dwordx4 v242, s[12:15], s49 offen lds
    s_add_u32 s49, s49, 81920
    s_add_u32 s63, s63, 20480
    s_cmp_eq_u32 s63, 122880
    s_cselect_b32 s63, 0, s63
    s_cmp_lt_u32 s60, 10
    s_cselect_b32 s61, s62, 0x7ffffff0
    s_add_u32 s60, s60, 1
    s_add_u32 s62, s62, 128
    s_add_u32 m0, s63, s64
    s_nop 0
    buffer_load_dwordx4 v10, s[8:11], s61 offen lds
    s_add_u32 m0, m0, 1024
    s_nop 0
    buffer_load_dwordx4 v11, s[8:11], s61 offen lds
    s_add_u32 m0, s63, s65
    s_nop 0
    buffer_load_dwordx4 v240, s[12:15], s49 offen lds
    s_add_u32 m0, m0, 1024
    s_nop 0
    buffer_load_dwordx4 v241, s[12:15], s49 offen lds
    s_add_u32 m0, m0, 1024
    s_nop 0
    buffer_load_dwordx4 v242, s[12:15], s49 offen lds
    s_add_u32 s49, s49, 81920
    s_add_u32 s63, s63, 20480
    s_cmp_eq_u32 s63, 122880
    s_cselect_b32 s63, 0, s63
    s_lshr_b32 s53, s42, 0
    s_and_b32 s54, s42, 0
    v_and_b32 v3, 15, v2
    v_lshrrev_b32 v4, 4, v2
    v_and_b32 v22, 7, v3
    v_xor_b32 v22, v22, v4
    v_lshlrev_b32 v22, 4, v22
    v_lshl_add_u32 v22, v3, 7, v22
    s_mul_i32 s55, s53, 2048
    v_add_u32 v22, s55, v22
    v_xor_b32 v23, 64, v22
    v_lshrrev_b32 v24, 2, v3
    v_lshl_add_u32 v24, v4, 3, v24
    v_mul_u32_u24 v24, 160, v24
    v_and_b32 v25, 3, v2
    v_lshl_add_u32 v24, v25, 3, v24
    s_mul_i32 s55, s54, 160
    s_add_u32 s55, s55, 8192
    v_add_u32 v24, s55, v24
    v_mov_b32 v72, 0
    v_mov_b32 v73, 0
    v_mov_b32 v74, 0
    v_mov_b32 v75, 0
    v_mov_b32 v76, 0
    v_mov_b32 v77, 0
    v_mov_b32 v78, 0
    v_mov_b32 v79, 0
    v_mov_b32 v80, 0
    v_mov_b32 v81, 0
    v_mov_b32 v82, 0
    v_mov_b32 v83, 0
    v_mov_b32 v84, 0
    v_mov_b32 v85, 0
    v_mov_b32 v86, 0
    v_mov_b32 v87, 0
    v_mov_b32 v88, 0
    v_mov_b32 v89, 0
    v_mov_b32 v90, 0
    v_mov_b32 v91, 0
    v_mov_b32 v60, 0
    v_mov_b32 v62, 0
    v_mov_b32 v64, 0x3f803f80
    v_mov_b32 v40, 0
    v_mov_b32 v41, 0
    v_mov_b32 v42, 0
    v_mov_b32 v43, 0
    v_mov_b32 v44, 0
    s_mov_b32 s66, 0
    s_mov_b32 s51, 10
k4_w1_kernel_loop:
    s_waitcnt vmcnt(20)
    s_barrier
    v_add_u32 v26, s66, v22
    v_add_u32 v27, s66, v23
    v_add_u32 v28, s66, v24
    ds_read_b128 v[92:95], v26 offset:0
    ds_read_b64_tr_b16 v[96:97], v28 offset:0
    ds_read_b64_tr_b16 v[98:99], v28 offset:640
    ds_read_b64_tr_b16 v[100:101], v28 offset:32
    ds_read_b64_tr_b16 v[102:103], v28 offset:672
    ds_read_b64_tr_b16 v[104:105], v28 offset:64
    ds_read_b64_tr_b16 v[106:107], v28 offset:704
    ds_read_b64_tr_b16 v[108:109], v28 offset:96
    ds_read_b64_tr_b16 v[110:111], v28 offset:736
    ds_read_b64_tr_b16 v[112:113], v28 offset:128
    ds_read_b64_tr_b16 v[114:115], v28 offset:768
    ds_read_b128 v[116:119], v27 offset:0
    ds_read_b64_tr_b16 v[120:121], v28 offset:5120
    ds_read_b64_tr_b16 v[122:123], v28 offset:5760
    ds_read_b64_tr_b16 v[124:125], v28 offset:5152
    ds_read_b64_tr_b16 v[126:127], v28 offset:5792
    ds_read_b64_tr_b16 v[128:129], v28 offset:5184
    ds_read_b64_tr_b16 v[130:131], v28 offset:5824
    ds_read_b64_tr_b16 v[132:133], v28 offset:5216
    ds_read_b64_tr_b16 v[134:135], v28 offset:5856
    ds_read_b64_tr_b16 v[136:137], v28 offset:5248
    ds_read_b64_tr_b16 v[138:139], v28 offset:5888
    s_cmp_lt_u32 s60, 10
    s_cselect_b32 s61, s62, 0x7ffffff0
    s_add_u32 s60, s60, 1
    s_add_u32 s62, s62, 128
    s_add_u32 m0, s63, s64
    s_nop 0
    buffer_load_dwordx4 v10, s[8:11], s61 offen lds
    s_add_u32 m0, m0, 1024
    s_nop 0
    buffer_load_dwordx4 v11, s[8:11], s61 offen lds
    s_add_u32 m0, s63, s65
    s_nop 0
    buffer_load_dwordx4 v240, s[12:15], s49 offen lds
    s_add_u32 m0, m0, 1024
    s_nop 0
    buffer_load_dwordx4 v241, s[12:15], s49 offen lds
    s_add_u32 m0, m0, 1024
    s_nop 0
    buffer_load_dwordx4 v242, s[12:15], s49 offen lds
    s_add_u32 s49, s49, 81920
    s_add_u32 s63, s63, 20480
    s_cmp_eq_u32 s63, 122880
    s_cselect_b32 s63, 0, s63
    s_waitcnt lgkmcnt(11)
    v_mfma_f32_16x16x32_bf16 v[72:75], v[96:99], v[92:95], v[72:75]
    v_mfma_f32_16x16x32_bf16 v[76:79], v[100:103], v[92:95], v[76:79]
    v_mfma_f32_16x16x32_bf16 v[80:83], v[104:107], v[92:95], v[80:83]
    v_mfma_f32_16x16x32_bf16 v[84:87], v[108:111], v[92:95], v[84:87]
    v_mfma_f32_16x16x32_bf16 v[88:91], v[112:115], v[92:95], v[88:91]
    v_dot2_f32_bf16 v60, v92, v64, v60
    v_dot2_f32_bf16 v62, v92, v92, v62
    v_dot2_f32_bf16 v60, v93, v64, v60
    v_dot2_f32_bf16 v62, v93, v93, v62
    v_dot2_f32_bf16 v60, v94, v64, v60
    v_dot2_f32_bf16 v62, v94, v94, v62
    v_dot2_f32_bf16 v60, v95, v64, v60
    v_dot2_f32_bf16 v62, v95, v95, v62
    v_dot2_f32_bf16 v40, v96, v64, v40
    v_dot2_f32_bf16 v40, v97, v64, v40
    v_dot2_f32_bf16 v40, v98, v64, v40
    v_dot2_f32_bf16 v40, v99, v64, v40
    v_dot2_f32_bf16 v41, v100, v64, v41
    v_dot2_f32_bf16 v41, v101, v64, v41
    v_dot2_f32_bf16 v41, v102, v64, v41
    v_dot2_f32_bf16 v41, v103, v64, v41
    v_dot2_f32_bf16 v42, v104, v64, v42
    v_dot2_f32_bf16 v42, v105, v64, v42
    v_dot2_f32_bf16 v42, v106, v64, v42
    v_dot2_f32_bf16 v42, v107, v64, v42
    v_dot2_f32_bf16 v43, v108, v64, v43
    v_dot2_f32_bf16 v43, v109, v64, v43
    v_dot2_f32_bf16 v43, v110, v64, v43
    v_dot2_f32_bf16 v43, v111, v64, v43
    v_dot2_f32_bf16 v44, v112, v64, v44
    v_dot2_f32_bf16 v44, v113, v64, v44
    v_dot2_f32_bf16 v44, v114, v64, v44
    v_dot2_f32_bf16 v44, v115, v64, v44
    s_waitcnt lgkmcnt(0)
    v_mfma_f32_16x16x32_bf16 v[72:75], v[120:123], v[116:119], v[72:75]
    v_mfma_f32_16x16x32_bf16 v[76:79], v[124:127], v[116:119], v[76:79]
    v_mfma_f32_16x16x32_bf16 v[80:83], v[128:131], v[116:119], v[80:83]
    v_mfma_f32_16x16x32_bf16 v[84:87], v[132:135], v[116:119], v[84:87]
    v_mfma_f32_16x16x32_bf16 v[88:91], v[136:139], v[116:119], v[88:91]
    v_dot2_f32_bf16 v60, v116, v64, v60
    v_dot2_f32_bf16 v62, v116, v116, v62
    v_dot2_f32_bf16 v60, v117, v64, v60
    v_dot2_f32_bf16 v62, v117, v117, v62
    v_dot2_f32_bf16 v60, v118, v64, v60
    v_dot2_f32_bf16 v62, v118, v118, v62
    v_dot2_f32_bf16 v60, v119, v64, v60
    v_dot2_f32_bf16 v62, v119, v119, v62
    v_dot2_f32_bf16 v40, v120, v64, v40
    v_dot2_f32_bf16 v40, v121, v64, v40
    v_dot2_f32_bf16 v40, v122, v64, v40
    v_dot2_f32_bf16 v40, v123, v64, v40
    v_dot2_f32_bf16 v41, v124, v64, v41
    v_dot2_f32_bf16 v41, v125, v64, v41
    v_dot2_f32_bf16 v41, v126, v64, v41
    v_dot2_f32_bf16 v41, v127, v64, v41
    v_dot2_f32_bf16 v42, v128, v64, v42
    v_dot2_f32_bf16 v42, v129, v64, v42
    v_dot2_f32_bf16 v42, v130, v64, v42
    v_dot2_f32_bf16 v42, v131, v64, v42
    v_dot2_f32_bf16 v43, v132, v64, v43
    v_dot2_f32_bf16 v43, v133, v64, v43
    v_dot2_f32_bf16 v43, v134, v64, v43
    v_dot2_f32_bf16 v43, v135, v64, v43
    v_dot2_f32_bf16 v44, v136, v64, v44
    v_dot2_f32_bf16 v44, v137, v64, v44
    v_dot2_f32_bf16 v44, v138, v64, v44
    v_dot2_f32_bf16 v44, v139, v64, v44
    s_add_u32 s66, s66, 20480
    s_cmp_eq_u32 s66, 122880
    s_cselect_b32 s66, 0, s66
    s_sub_u32 s51, s51, 1
    s_cmp_lg_u32 s51, 0
    s_cbranch_scc1 k4_w1_kernel_loop
    s_waitcnt vmcnt(0)
    s_barrier
    s_nop 7
    ds_swizzle_b32 v100, v60 offset:0x401F
    ds_swizzle_b32 v101, v62 offset:0x401F
    ds_swizzle_b32 v102, v40 offset:0x401F
    ds_swizzle_b32 v103, v41 offset:0x401F
    ds_swizzle_b32 v104, v42 offset:0x401F
    ds_swizzle_b32 v105, v43 offset:0x401F
    ds_swizzle_b32 v106, v44 offset:0x401F
    s_waitcnt lgkmcnt(0)
    v_add_f32 v60, v60, v100
    v_mov_b32 v100, v60
    v_add_f32 v62, v62, v101
    v_mov_b32 v101, v62
    v_add_f32 v40, v40, v102
    v_mov_b32 v102, v40
    v_add_f32 v41, v41, v103
    v_mov_b32 v103, v41
    v_add_f32 v42, v42, v104
    v_mov_b32 v104, v42
    v_add_f32 v43, v43, v105
    v_mov_b32 v105, v43
    v_add_f32 v44, v44, v106
    v_mov_b32 v106, v44
    s_nop 1
    v_permlane32_swap_b32 v60, v100
    v_permlane32_swap_b32 v62, v101
    v_permlane32_swap_b32 v40, v102
    v_permlane32_swap_b32 v41, v103
    v_permlane32_swap_b32 v42, v104
    v_permlane32_swap_b32 v43, v105
    v_permlane32_swap_b32 v44, v106
    s_nop 1
    v_add_f32 v60, v60, v100
    v_add_f32 v62, v62, v101
    v_add_f32 v40, v40, v102
    v_add_f32 v41, v41, v103
    v_add_f32 v42, v42, v104
    v_add_f32 v43, v43, v105
    v_add_f32 v44, v44, v106
    s_mul_i32 s57, s42, 320
    v_lshl_add_u32 v50, v3, 2, s57
    v_lshl_add_u32 v51, v4, 4, s57
    ds_write_b32 v50, v40 offset:0
    ds_write_b32 v50, v41 offset:64
    ds_write_b32 v50, v42 offset:128
    ds_write_b32 v50, v43 offset:192
    ds_write_b32 v50, v44 offset:256
    v_mul_f32 v60, 0x3acccccd, v60
    v_mul_f32 v62, 0x3acccccd, v62
    v_fma_f32 v62, -v60, v60, v62
    v_add_f32 v50, 0x3727c5ac, v62
    v_rsq_f32 v66, v50
    s_nop 0
    v_mul_f32 v50, v62, v66
    v_mul_f32 v50, v50, v66
    v_add_f32 v50, 0x3727c5ac, v50
    v_rsq_f32 v50, v50
    s_nop 0
    v_mul_f32 v62, v50, v66
    s_waitcnt lgkmcnt(0)
    ds_read_b128 v[92:95], v51 offset:0
    ds_read_b128 v[96:99], v51 offset:64
    ds_read_b128 v[100:103], v51 offset:128
    ds_read_b128 v[104:107], v51 offset:192
    ds_read_b128 v[108:111], v51 offset:256
    s_cmp_lg_u32 s33, 0
    s_cbranch_scc1 k4_w1_kernel_nost
    s_add_u32 s28, s4, 3670016
    s_addc_u32 s29, s5, 0
    s_and_b32 s29, s29, 0xffff
    s_mov_b32 s30, 16384
    s_mov_b32 s31, 0x00020000
    v_cmp_gt_u32 vcc, 16, v2
    s_and_saveexec_b64 s[58:59], vcc
    v_lshlrev_b32 v50, 3, v5
    v_mov_b32 v52, v60
    v_mov_b32 v53, v66
    buffer_store_dwordx2 v[52:53], v50, s[28:31], 0 offen offset:0
    s_mov_b64 exec, s[58:59]
k4_w1_kernel_nost:
    s_waitcnt lgkmcnt(0)
    v_fma_f32 v72, -v60, v92, v72
    v_mul_f32 v72, v72, v62
    v_fma_f32 v73, -v60, v93, v73
    v_mul_f32 v73, v73, v62
    v_fma_f32 v74, -v60, v94, v74
    v_mul_f32 v74, v74, v62
    v_fma_f32 v75, -v60, v95, v75
    v_mul_f32 v75, v75, v62
    v_fma_f32 v76, -v60, v96, v76
    v_mul_f32 v76, v76, v62
    v_fma_f32 v77, -v60, v97, v77
    v_mul_f32 v77, v77, v62
    v_fma_f32 v78, -v60, v98, v78
    v_mul_f32 v78, v78, v62
    v_fma_f32 v79, -v60, v99, v79
    v_mul_f32 v79, v79, v62
    v_fma_f32 v80, -v60, v100, v80
    v_mul_f32 v80, v80, v62
    v_fma_f32 v81, -v60, v101, v81
    v_mul_f32 v81, v81, v62
    v_fma_f32 v82, -v60, v102, v82
    v_mul_f32 v82, v82, v62
    v_fma_f32 v83, -v60, v103, v83
    v_mul_f32 v83, v83, v62
    v_fma_f32 v84, -v60, v104, v84
    v_mul_f32 v84, v84, v62
    v_fma_f32 v85, -v60, v105, v85
    v_mul_f32 v85, v85, v62
    v_fma_f32 v86, -v60, v106, v86
    v_mul_f32 v86, v86, v62
    v_fma_f32 v87, -v60, v107, v87
    v_mul_f32 v87, v87, v62
    v_fma_f32 v88, -v60, v108, v88
    v_mul_f32 v88, v88, v62
    v_fma_f32 v89, -v60, v109, v89
    v_mul_f32 v89, v89, v62
    v_fma_f32 v90, -v60, v110, v90
    v_mul_f32 v90, v90, v62
    v_fma_f32 v91, -v60, v111, v91
    v_mul_f32 v91, v91, v62
    s_waitcnt vmcnt(0)
    s_add_u32 s16, s4, 13631488
    s_addc_u32 s17, s5, 0
    s_and_b32 s17, s17, 0xffff
    s_mov_b32 s18, 2621440
    s_mov_b32 s19, 0x00020000
    v_mov_b32 v58, 0x3d372713
    s_mov_b32 s70, 0
k4_w1_kernel_gl:
    s_set_gpr_idx_on s70, gpr_idx(SRC0)
    v_mov_b32 v50, v72
    v_mov_b32 v51, v73
    v_mov_b32 v52, v74
    v_mov_b32 v53, v75
    s_set_gpr_idx_off
    v_mul_f32 v54, v50, v50
    v_mul_f32 v55, v51, v51
    v_mul_f32 v56, v52, v52
    v_mul_f32 v57, v53, v53
    v_fma_f32 v54, v54, v58, 1.0
    v_fma_f32 v55, v55, v58, 1.0
    v_fma_f32 v56, v56, v58, 1.0
    v_fma_f32 v57, v57, v58, 1.0
    v_mul_f32 v54, v54, v50
    v_mul_f32 v55, v55, v51
    v_mul_f32 v56, v56, v52
    v_mul_f32 v57, v57, v53
    v_mul_f32 v54, 0xc0135761, v54
    v_mul_f32 v55, 0xc0135761, v55
    v_mul_f32 v56, 0xc0135761, v56
    v_mul_f32 v57, 0xc0135761, v57
    v_exp_f32 v54, v54
    v_exp_f32 v55, v55
    v_exp_f32 v56, v56
    v_exp_f32 v57, v57
    s_nop 0
    v_add_f32 v54, 1.0, v54
    v_add_f32 v55, 1.0, v55
    v_add_f32 v56, 1.0, v56
    v_add_f32 v57, 1.0, v57
    v_rcp_f32 v54, v54
    v_rcp_f32 v55, v55
    v_rcp_f32 v56, v56
    v_rcp_f32 v57, v57
    s_nop 0
    v_mul_f32 v50, v50, v54
    v_mul_f32 v51, v51, v55
    v_mul_f32 v52, v52, v56
    v_mul_f32 v53, v53, v57
    s_set_gpr_idx_on s70, gpr_idx(DST)
    v_mov_b32 v72, v50
    v_mov_b32 v73, v51
    v_mov_b32 v74, v52
    v_mov_b32 v75, v53
    s_set_gpr_idx_off
    s_add_u32 s70, s70, 4
    s_cmp_lt_u32 s70, 20
    s_cbranch_scc1 k4_w1_kernel_gl
    v_cvt_pk_bf16_f32 v50, v72, v73
    v_cvt_pk_bf16_f32 v51, v74, v75
    buffer_store_dwordx2 v[50:51], v7, s[16:19], 0 offen offset:0
    v_cvt_pk_bf16_f32 v50, v76, v77
    v_cvt_pk_bf16_f32 v51, v78, v79
    buffer_store_dwordx2 v[50:51], v7, s[16:19], 0 offen offset:32
    v_cvt_pk_bf16_f32 v50, v80, v81
    v_cvt_pk_bf16_f32 v51, v82, v83
    buffer_store_dwordx2 v[50:51], v7, s[16:19], 0 offen offset:64
    v_cvt_pk_bf16_f32 v50, v84, v85
    v_cvt_pk_bf16_f32 v51, v86, v87
    buffer_store_dwordx2 v[50:51], v7, s[16:19], 0 offen offset:96
    v_cvt_pk_bf16_f32 v50, v88, v89
    v_cvt_pk_bf16_f32 v51, v90, v91
    buffer_store_dwordx2 v[50:51], v7, s[16:19], 0 offen offset:128
    s_waitcnt vmcnt(0)
    s_branch k4_w1_kernel_end
k4_w1_kernel_end:
    s_endpgm
.globl k5_w2_kernel
.p2align 8
.type k5_w2_kernel,@function
k5_w2_kernel:
    s_cmp_ge_u32 s2, 256
    s_cbranch_scc1 k5_w2_kernel_end
    s_load_dwordx2 s[4:5], s[0:1], 96
    s_load_dwordx2 s[6:7], s[0:1], 56
    s_mul_hi_u32 s32, s2, 536870913
    s_mul_i32 s33, s32, 8
    s_sub_u32 s33, s2, s33
    s_lshl_b32 s40, s32, 6
    s_mul_i32 s41, s33, 80
    v_lshrrev_b32 v1, 6, v0
    v_and_b32 v2, 63, v0
    v_readfirstlane_b32 s42, v1
    v_lshrrev_b32 v8, 3, v2
    v_and_b32 v9, 7, v2
    v_xor_b32 v9, v9, v8
    s_lshl_b32 s43, s42, 4
    s_add_u32 s43, s43, s40
    v_add_u32 v10, s43, v8
    s_mov_b32 s45, 1280
    v_mul_lo_u32 v10, v10, s45
    v_lshl_add_u32 v10, v9, 4, v10
    v_add_u32 v11, 10240, v10
    s_mov_b32 s46, 1280
    s_mov_b32 s48, 429496730
    s_lshl_b32 s47, s41, 1
    s_mul_i32 s44, s42, 192
    v_add_u32 v50, s44, v2
    v_mul_hi_u32 v51, v50, s48
    v_mul_u32_u24 v52, 10, v51
    v_sub_u32 v52, v50, v52
    v_mul_lo_u32 v53, v51, s46
    v_lshl_add_u32 v53, v52, 4, v53
    v_add_u32 v240, s47, v53
    v_mov_b32 v53, 0x7ffffff0
    v_cmp_le_u32 vcc, 640, v50
    s_nop 1
    v_cndmask_b32 v240, v240, v53, vcc
    v_add_u32 v50, s44, v2
    v_add_u32 v50, 64, v50
    v_mul_hi_u32 v51, v50, s48
    v_mul_u32_u24 v52, 10, v51
    v_sub_u32 v52, v50, v52
    v_mul_lo_u32 v53, v51, s46
    v_lshl_add_u32 v53, v52, 4, v53
    v_add_u32 v241, s47, v53
    v_mov_b32 v53, 0x7ffffff0
    v_cmp_le_u32 vcc, 640, v50
    s_nop 1
    v_cndmask_b32 v241, v241, v53, vcc
    v_add_u32 v50, s44, v2
    v_add_u32 v50, 128, v50
    v_mul_hi_u32 v51, v50, s48
    v_mul_u32_u24 v52, 10, v51
    v_sub_u32 v52, v50, v52
    v_mul_lo_u32 v53, v51, s46
    v_lshl_add_u32 v53, v52, 4, v53
    v_add_u32 v242, s47, v53
    v_mov_b32 v53, 0x7ffffff0
    v_cmp_le_u32 vcc, 640, v50
    s_nop 1
    v_cndmask_b32 v242, v242, v53, vcc
    s_waitcnt lgkmcnt(0)
    s_add_u32 s8, s4, 13631488
    s_addc_u32 s9, s5, 0
    s_and_b32 s9, s9, 0xffff
    s_mov_b32 s10, 2621440
    s_mov_b32 s11, 0x00020000
    s_mov_b32 s12, s6
    s_mov_b32 s13, s7
    s_and_b32 s13, s13, 0xffff
    s_mov_b32 s14, 819200
    s_mov_b32 s15, 0x00020000
    s_mov_b32 s49, 0
    s_mov_b32 s50, 0
    s_mov_b32 s60, 0
    s_mov_b32 s62, 0
    s_mov_b32 s63, 0
    s_lshl_b32 s64, s42, 11
    s_mul_i32 s65, s42, 3072
    s_add_u32 s65, s65, 8192
    s_lshr_b32 s53, s42, 0
    s_and_b32 s54, s42, 0
    v_and_b32 v3, 15, v2
    v_lshrrev_b32 v4, 4, v2
    s_mul_i32 s55, s53, 16
    s_add_u32 s55, s55, s40
    v_add_u32 v5, s55, v3
    s_mul_i32 s56, s54, 80
    s_add_u32 s56, s56, s41
    v_lshl_add_u32 v6, v4, 2, s56
    s_mov_b32 s44, 1280
    v_mul_lo_u32 v7, v5, s44
    v_lshl_add_u32 v7, v6, 1, v7
    v_add_u32 v16, 20480, v7
    s_add_u32 s20, s4, 7340032
    s_addc_u32 s21, s5, 0
    s_and_b32 s21, s21, 0xffff
    s_mov_b32 s22, 2621440
    s_mov_b32 s23, 0x00020000
    buffer_load_dwordx2 v[140:141], v7, s[20:23], 0 offen offset:0
    buffer_load_dwordx2 v[142:143], v7, s[20:23], 0 offen offset:32
    buffer_load_dwordx2 v[144:145], v7, s[20:23], 0 offen offset:64
    buffer_load_dwordx2 v[146:147], v7, s[20:23], 0 offen offset:96
    buffer_load_dwordx2 v[148:149], v7, s[20:23], 0 offen offset:128
    s_add_u32 s24, s4, 3670016
    s_addc_u32 s25, s5, 0
    s_and_b32 s25, s25, 0xffff
    s_mov_b32 s26, 16384
    s_mov_b32 s27, 0x00020000
    v_lshlrev_b32 v50, 3, v5
    buffer_load_dwordx2 v[56:57], v50, s[24:27], 0 offen offset:0
    s_cmp_lt_u32 s60, 10
    s_cselect_b32 s61, s62, 0x7ffffff0
    s_add_u32 s60, s60, 1
    s_add_u32 s62, s62, 128
    v_add_u32 v12, s50, v9
    v_mov_b32 v13, 4294966016
    v_cmp_le_u32 vcc, 20, v12
    v_mov_b32 v14, 1280
    v_cndmask_b32 v13, v13, v14, vcc
    v_cmp_le_u32 vcc, 40, v12
    v_mov_b32 v14, 4294964736
    v_cndmask_b32 v13, v13, v14, vcc
    v_cmp_le_u32 vcc, 60, v12
    v_mov_b32 v14, 2560
    v_cndmask_b32 v13, v13, v14, vcc
    v_add_u32 v14, v13, v10
    v_add_u32 v15, v13, v11
    s_add_u32 s50, s50, 8
    s_add_u32 m0, s63, s64
    s_nop 0
    buffer_load_dwordx4 v14, s[8:11], s61 offen lds
    s_add_u32 m0, m0, 1024
    s_nop 0
    buffer_load_dwordx4 v15, s[8:11], s61 offen lds
    s_add_u32 m0, s63, s65
    s_nop 0
    buffer_load_dwordx4 v240, s[12:15], s49 offen lds
    s_add_u32 m0, m0, 1024
    s_nop 0
    buffer_load_dwordx4 v241, s[12:15], s49 offen lds
    s_add_u32 m0, m0, 1024
    s_nop 0
    buffer_load_dwordx4 v242, s[12:15], s49 offen lds
    s_add_u32 s49, s49, 81920
    s_add_u32 s63, s63, 20480
    s_cmp_eq_u32 s63, 122880
    s_cselect_b32 s63, 0, s63
    s_cmp_lt_u32 s60, 10
    s_cselect_b32 s61, s62, 0x7ffffff0
    s_add_u32 s60, s60, 1
    s_add_u32 s62, s62, 128
    v_add_u32 v12, s50, v9
    v_mov_b32 v13, 4294966016
    v_cmp_le_u32 vcc, 20, v12
    v_mov_b32 v14, 1280
    v_cndmask_b32 v13, v13, v14, vcc
    v_cmp_le_u32 vcc, 40, v12
    v_mov_b32 v14, 4294964736
    v_cndmask_b32 v13, v13, v14, vcc
    v_cmp_le_u32 vcc, 60, v12
    v_mov_b32 v14, 2560
    v_cndmask_b32 v13, v13, v14, vcc
    v_add_u32 v14, v13, v10
    v_add_u32 v15, v13, v11
    s_add_u32 s50, s50, 8
    s_add_u32 m0, s63, s64
    s_nop 0
    buffer_load_dwordx4 v14, s[8:11], s61 offen lds
    s_add_u32 m0, m0, 1024
    s_nop 0
    buffer_load_dwordx4 v15, s[8:11], s61 offen lds
    s_add_u32 m0, s63, s65
    s_nop 0
    buffer_load_dwordx4 v240, s[12:15], s49 offen lds
    s_add_u32 m0, m0, 1024
    s_nop 0
    buffer_load_dwordx4 v241, s[12:15], s49 offen lds
    s_add_u32 m0, m0, 1024
    s_nop 0
    buffer_load_dwordx4 v242, s[12:15], s49 offen lds
    s_add_u32 s49, s49, 81920
    s_add_u32 s63, s63, 20480
    s_cmp_eq_u32 s63, 122880
    s_cselect_b32 s63, 0, s63
    s_cmp_lt_u32 s60, 10
    s_cselect_b32 s61, s62, 0x7ffffff0
    s_add_u32 s60, s60, 1
    s_add_u32 s62, s62, 128
    v_add_u32 v12, s50, v9
    v_mov_b32 v13, 4294966016
    v_cmp_le_u32 vcc, 20, v12
    v_mov_b32 v14, 1280
    v_cndmask_b32 v13, v13, v14, vcc
    v_cmp_le_u32 vcc, 40, v12
    v_mov_b32 v14, 4294964736
    v_cndmask_b32 v13, v13, v14, vcc
    v_cmp_le_u32 vcc, 60, v12
    v_mov_b32 v14, 2560
    v_cndmask_b32 v13, v13, v14, vcc
    v_add_u32 v14, v13, v10
    v_add_u32 v15, v13, v11
    s_add_u32 s50, s50, 8
    s_add_u32 m0, s63, s64
    s_nop 0
    buffer_load_dwordx4 v14, s[8:11], s61 offen lds
    s_add_u32 m0, m0, 1024
    s_nop 0
    buffer_load_dwordx4 v15, s[8:11], s61 offen lds
    s_add_u32 m0, s63, s65
    s_nop 0
    buffer_load_dwordx4 v240, s[12:15], s49 offen lds
    s_add_u32 m0, m0, 1024
    s_nop 0
    buffer_load_dwordx4 v241, s[12:15], s49 offen lds
    s_add_u32 m0, m0, 1024
    s_nop 0
    buffer_load_dwordx4 v242, s[12:15], s49 offen lds
    s_add_u32 s49, s49, 81920
    s_add_u32 s63, s63, 20480
    s_cmp_eq_u32 s63, 122880
    s_cselect_b32 s63, 0, s63
    s_cmp_lt_u32 s60, 10
    s_cselect_b32 s61, s62, 0x7ffffff0
    s_add_u32 s60, s60, 1
    s_add_u32 s62, s62, 128
    v_add_u32 v12, s50, v9
    v_mov_b32 v13, 4294966016
    v_cmp_le_u32 vcc, 20, v12
    v_mov_b32 v14, 1280
    v_cndmask_b32 v13, v13, v14, vcc
    v_cmp_le_u32 vcc, 40, v12
    v_mov_b32 v14, 4294964736
    v_cndmask_b32 v13, v13, v14, vcc
    v_cmp_le_u32 vcc, 60, v12
    v_mov_b32 v14, 2560
    v_cndmask_b32 v13, v13, v14, vcc
    v_add_u32 v14, v13, v10
    v_add_u32 v15, v13, v11
    s_add_u32 s50, s50, 8
    s_add_u32 m0, s63, s64
    s_nop 0
    buffer_load_dwordx4 v14, s[8:11], s61 offen lds
    s_add_u32 m0, m0, 1024
    s_nop 0
    buffer_load_dwordx4 v15, s[8:11], s61 offen lds
    s_add_u32 m0, s63, s65
    s_nop 0
    buffer_load_dwordx4 v240, s[12:15], s49 offen lds
    s_add_u32 m0, m0, 1024
    s_nop 0
    buffer_load_dwordx4 v241, s[12:15], s49 offen lds
    s_add_u32 m0, m0, 1024
    s_nop 0
    buffer_load_dwordx4 v242, s[12:15], s49 offen lds
    s_add_u32 s49, s49, 81920
    s_add_u32 s63, s63, 20480
    s_cmp_eq_u32 s63, 122880
    s_cselect_b32 s63, 0, s63
    s_cmp_lt_u32 s60, 10
    s_cselect_b32 s61, s62, 0x7ffffff0
    s_add_u32 s60, s60, 1
    s_add_u32 s62, s62, 128
    v_add_u32 v12, s50, v9
    v_mov_b32 v13, 4294966016
    v_cmp_le_u32 vcc, 20, v12
    v_mov_b32 v14, 1280
    v_cndmask_b32 v13, v13, v14, vcc
    v_cmp_le_u32 vcc, 40, v12
    v_mov_b32 v14, 4294964736
    v_cndmask_b32 v13, v13, v14, vcc
    v_cmp_le_u32 vcc, 60, v12
    v_mov_b32 v14, 2560
    v_cndmask_b32 v13, v13, v14, vcc
    v_add_u32 v14, v13, v10
    v_add_u32 v15, v13, v11
    s_add_u32 s50, s50, 8
    s_add_u32 m0, s63, s64
    s_nop 0
    buffer_load_dwordx4 v14, s[8:11], s61 offen lds
    s_add_u32 m0, m0, 1024
    s_nop 0
    buffer_load_dwordx4 v15, s[8:11], s61 offen lds
    s_add_u32 m0, s63, s65
    s_nop 0
    buffer_load_dwordx4 v240, s[12:15], s49 offen lds
    s_add_u32 m0, m0, 1024
    s_nop 0
    buffer_load_dwordx4 v241, s[12:15], s49 offen lds
    s_add_u32 m0, m0, 1024
    s_nop 0
    buffer_load_dwordx4 v242, s[12:15], s49 offen lds
    s_add_u32 s49, s49, 81920
    s_add_u32 s63, s63, 20480
    s_cmp_eq_u32 s63, 122880
    s_cselect_b32 s63, 0, s63
    s_lshr_b32 s53, s42, 0
    s_and_b32 s54, s42, 0
    v_and_b32 v3, 15, v2
    v_lshrrev_b32 v4, 4, v2
    v_and_b32 v22, 7, v3
    v_xor_b32 v22, v22, v4
    v_lshlrev_b32 v22, 4, v22
    v_lshl_add_u32 v22, v3, 7, v22
    s_mul_i32 s55, s53, 2048
    v_add_u32 v22, s55, v22
    v_xor_b32 v23, 64, v22
    v_lshrrev_b32 v24, 2, v3
    v_lshl_add_u32 v24, v4, 3, v24
    v_mul_u32_u24 v24, 160, v24
    v_and_b32 v25, 3, v2
    v_lshl_add_u32 v24, v25, 3, v24
    s_mul_i32 s55, s54, 160
    s_add_u32 s55, s55, 8192
    v_add_u32 v24, s55, v24
    v_mov_b32 v72, 0
    v_mov_b32 v73, 0
    v_mov_b32 v74, 0
    v_mov_b32 v75, 0
    v_mov_b32 v76, 0
    v_mov_b32 v77, 0
    v_mov_b32 v78, 0
    v_mov_b32 v79, 0
    v_mov_b32 v80, 0
    v_mov_b32 v81, 0
    v_mov_b32 v82, 0
    v_mov_b32 v83, 0
    v_mov_b32 v84, 0
    v_mov_b32 v85, 0
    v_mov_b32 v86, 0
    v_mov_b32 v87, 0
    v_mov_b32 v88, 0
    v_mov_b32 v89, 0
    v_mov_b32 v90, 0
    v_mov_b32 v91, 0
    v_mov_b32 v60, 0
    v_mov_b32 v62, 0
    v_mov_b32 v64, 0x3f803f80
    s_mov_b32 s66, 0
    s_mov_b32 s51, 10
k5_w2_kernel_loop:
    s_waitcnt vmcnt(20)
    s_barrier
    v_add_u32 v26, s66, v22
    v_add_u32 v27, s66, v23
    v_add_u32 v28, s66, v24
    ds_read_b128 v[92:95], v26 offset:0
    ds_read_b64_tr_b16 v[96:97], v28 offset:0
    ds_read_b64_tr_b16 v[98:99], v28 offset:640
    ds_read_b64_tr_b16 v[100:101], v28 offset:32
    ds_read_b64_tr_b16 v[102:103], v28 offset:672
    ds_read_b64_tr_b16 v[104:105], v28 offset:64
    ds_read_b64_tr_b16 v[106:107], v28 offset:704
    ds_read_b64_tr_b16 v[108:109], v28 offset:96
    ds_read_b64_tr_b16 v[110:111], v28 offset:736
    ds_read_b64_tr_b16 v[112:113], v28 offset:128
    ds_read_b64_tr_b16 v[114:115], v28 offset:768
    ds_read_b128 v[116:119], v27 offset:0
    ds_read_b64_tr_b16 v[120:121], v28 offset:5120
    ds_read_b64_tr_b16 v[122:123], v28 offset:5760
    ds_read_b64_tr_b16 v[124:125], v28 offset:5152
    ds_read_b64_tr_b16 v[126:127], v28 offset:5792
    ds_read_b64_tr_b16 v[128:129], v28 offset:5184
    ds_read_b64_tr_b16 v[130:131], v28 offset:5824
    ds_read_b64_tr_b16 v[132:133], v28 offset:5216
    ds_read_b64_tr_b16 v[134:135], v28 offset:5856
    ds_read_b64_tr_b16 v[136:137], v28 offset:5248
    ds_read_b64_tr_b16 v[138:139], v28 offset:5888
    s_cmp_lt_u32 s60, 10
    s_cselect_b32 s61, s62, 0x7ffffff0
    s_add_u32 s60, s60, 1
    s_add_u32 s62, s62, 128
    v_add_u32 v12, s50, v9
    v_mov_b32 v13, 4294966016
    v_cmp_le_u32 vcc, 20, v12
    v_mov_b32 v14, 1280
    v_cndmask_b32 v13, v13, v14, vcc
    v_cmp_le_u32 vcc, 40, v12
    v_mov_b32 v14, 4294964736
    v_cndmask_b32 v13, v13, v14, vcc
    v_cmp_le_u32 vcc, 60, v12
    v_mov_b32 v14, 2560
    v_cndmask_b32 v13, v13, v14, vcc
    v_add_u32 v14, v13, v10
    v_add_u32 v15, v13, v11
    s_add_u32 s50, s50, 8
    s_add_u32 m0, s63, s64
    s_nop 0
    buffer_load_dwordx4 v14, s[8:11], s61 offen lds
    s_add_u32 m0, m0, 1024
    s_nop 0
    buffer_load_dwordx4 v15, s[8:11], s61 offen lds
    s_add_u32 m0, s63, s65
    s_nop 0
    buffer_load_dwordx4 v240, s[12:15], s49 offen lds
    s_add_u32 m0, m0, 1024
    s_nop 0
    buffer_load_dwordx4 v241, s[12:15], s49 offen lds
    s_add_u32 m0, m0, 1024
    s_nop 0
    buffer_load_dwordx4 v242, s[12:15], s49 offen lds
    s_add_u32 s49, s49, 81920
    s_add_u32 s63, s63, 20480
    s_cmp_eq_u32 s63, 122880
    s_cselect_b32 s63, 0, s63
    s_waitcnt lgkmcnt(11)
    v_mfma_f32_16x16x32_bf16 v[72:75], v[96:99], v[92:95], v[72:75]
    v_mfma_f32_16x16x32_bf16 v[76:79], v[100:103], v[92:95], v[76:79]
    v_mfma_f32_16x16x32_bf16 v[80:83], v[104:107], v[92:95], v[80:83]
    v_mfma_f32_16x16x32_bf16 v[84:87], v[108:111], v[92:95], v[84:87]
    v_mfma_f32_16x16x32_bf16 v[88:91], v[112:115], v[92:95], v[88:91]
    s_waitcnt lgkmcnt(0)
    v_mfma_f32_16x16x32_bf16 v[72:75], v[120:123], v[116:119], v[72:75]
    v_mfma_f32_16x16x32_bf16 v[76:79], v[124:127], v[116:119], v[76:79]
    v_mfma_f32_16x16x32_bf16 v[80:83], v[128:131], v[116:119], v[80:83]
    v_mfma_f32_16x16x32_bf16 v[84:87], v[132:135], v[116:119], v[84:87]
    v_mfma_f32_16x16x32_bf16 v[88:91], v[136:139], v[116:119], v[88:91]
    s_add_u32 s66, s66, 20480
    s_cmp_eq_u32 s66, 122880
    s_cselect_b32 s66, 0, s66
    s_sub_u32 s51, s51, 1
    s_cmp_lg_u32 s51, 0
    s_cbranch_scc1 k5_w2_kernel_loop
    s_waitcnt vmcnt(0)
    s_barrier
    s_nop 7
    s_waitcnt vmcnt(0)
    s_add_u32 s16, s4, 16777216
    s_addc_u32 s17, s5, 0
    s_and_b32 s17, s17, 0xffff
    s_mov_b32 s18, 2621440
    s_mov_b32 s19, 0x00020000
    v_mul_f32 v60, v56, v57
    v_sub_f32 v60, 0, v60
    v_lshlrev_b32 v50, 16, v140
    v_and_b32 v51, 0xffff0000, v140
    v_fma_f32 v50, v50, v57, v60
    v_fma_f32 v51, v51, v57, v60
    v_cvt_pk_bf16_f32 v50, v50, v51
    v_and_b32 v51, 0xffff0000, v50
    v_lshlrev_b32 v50, 16, v50
    v_add_f32 v72, v72, v50
    v_add_f32 v73, v73, v51
    v_lshlrev_b32 v50, 16, v141
    v_and_b32 v51, 0xffff0000, v141
    v_fma_f32 v50, v50, v57, v60
    v_fma_f32 v51, v51, v57, v60
    v_cvt_pk_bf16_f32 v50, v50, v51
    v_and_b32 v51, 0xffff0000, v50
    v_lshlrev_b32 v50, 16, v50
    v_add_f32 v74, v74, v50
    v_add_f32 v75, v75, v51
    v_lshlrev_b32 v50, 16, v142
    v_and_b32 v51, 0xffff0000, v142
    v_fma_f32 v50, v50, v57, v60
    v_fma_f32 v51, v51, v57, v60
    v_cvt_pk_bf16_f32 v50, v50, v51
    v_and_b32 v51, 0xffff0000, v50
    v_lshlrev_b32 v50, 16, v50
    v_add_f32 v76, v76, v50
    v_add_f32 v77, v77, v51
    v_lshlrev_b32 v50, 16, v143
    v_and_b32 v51, 0xffff0000, v143
    v_fma_f32 v50, v50, v57, v60
    v_fma_f32 v51, v51, v57, v60
    v_cvt_pk_bf16_f32 v50, v50, v51
    v_and_b32 v51, 0xffff0000, v50
    v_lshlrev_b32 v50, 16, v50
    v_add_f32 v78, v78, v50
    v_add_f32 v79, v79, v51
    v_lshlrev_b32 v50, 16, v144
    v_and_b32 v51, 0xffff0000, v144
    v_fma_f32 v50, v50, v57, v60
    v_fma_f32 v51, v51, v57, v60
    v_cvt_pk_bf16_f32 v50, v50, v51
    v_and_b32 v51, 0xffff0000, v50
    v_lshlrev_b32 v50, 16, v50
    v_add_f32 v80, v80, v50
    v_add_f32 v81, v81, v51
    v_lshlrev_b32 v50, 16, v145
    v_and_b32 v51, 0xffff0000, v145
    v_fma_f32 v50, v50, v57, v60
    v_fma_f32 v51, v51, v57, v60
    v_cvt_pk_bf16_f32 v50, v50, v51
    v_and_b32 v51, 0xffff0000, v50
    v_lshlrev_b32 v50, 16, v50
    v_add_f32 v82, v82, v50
    v_add_f32 v83, v83, v51
    v_lshlrev_b32 v50, 16, v146
    v_and_b32 v51, 0xffff0000, v146
    v_fma_f32 v50, v50, v57, v60
    v_fma_f32 v51, v51, v57, v60
    v_cvt_pk_bf16_f32 v50, v50, v51
    v_and_b32 v51, 0xffff0000, v50
    v_lshlrev_b32 v50, 16, v50
    v_add_f32 v84, v84, v50
    v_add_f32 v85, v85, v51
    v_lshlrev_b32 v50, 16, v147
    v_and_b32 v51, 0xffff0000, v147
    v_fma_f32 v50, v50, v57, v60
    v_fma_f32 v51, v51, v57, v60
    v_cvt_pk_bf16_f32 v50, v50, v51
    v_and_b32 v51, 0xffff0000, v50
    v_lshlrev_b32 v50, 16, v50
    v_add_f32 v86, v86, v50
    v_add_f32 v87, v87, v51
    v_lshlrev_b32 v50, 16, v148
    v_and_b32 v51, 0xffff0000, v148
    v_fma_f32 v50, v50, v57, v60
    v_fma_f32 v51, v51, v57, v60
    v_cvt_pk_bf16_f32 v50, v50, v51
    v_and_b32 v51, 0xffff0000, v50
    v_lshlrev_b32 v50, 16, v50
    v_add_f32 v88, v88, v50
    v_add_f32 v89, v89, v51
    v_lshlrev_b32 v50, 16, v149
    v_and_b32 v51, 0xffff0000, v149
    v_fma_f32 v50, v50, v57, v60
    v_fma_f32 v51, v51, v57, v60
    v_cvt_pk_bf16_f32 v50, v50, v51
    v_and_b32 v51, 0xffff0000, v50
    v_lshlrev_b32 v50, 16, v50
    v_add_f32 v90, v90, v50
    v_add_f32 v91, v91, v51
    v_cvt_pk_bf16_f32 v50, v72, v73
    v_cvt_pk_bf16_f32 v51, v74, v75
    buffer_store_dwordx2 v[50:51], v7, s[16:19], 0 offen offset:0
    v_cvt_pk_bf16_f32 v50, v76, v77
    v_cvt_pk_bf16_f32 v51, v78, v79
    buffer_store_dwordx2 v[50:51], v7, s[16:19], 0 offen offset:32
    v_cvt_pk_bf16_f32 v50, v80, v81
    v_cvt_pk_bf16_f32 v51, v82, v83
    buffer_store_dwordx2 v[50:51], v7, s[16:19], 0 offen offset:64
    v_cvt_pk_bf16_f32 v50, v84, v85
    v_cvt_pk_bf16_f32 v51, v86, v87
    buffer_store_dwordx2 v[50:51], v7, s[16:19], 0 offen offset:96
    v_cvt_pk_bf16_f32 v50, v88, v89
    v_cvt_pk_bf16_f32 v51, v90, v91
    buffer_store_dwordx2 v[50:51], v7, s[16:19], 0 offen offset:128
    s_waitcnt vmcnt(0)
    s_branch k5_w2_kernel_end
k5_w2_kernel_end:
    s_endpgm
.globl k6_w3_kernel
.p2align 8
.type k6_w3_kernel,@function
k6_w3_kernel:
    s_cmp_ge_u32 s2, 256
    s_cbranch_scc1 k6_w3_kernel_end
    s_load_dwordx2 s[4:5], s[0:1], 96
    s_load_dwordx2 s[6:7], s[0:1], 64
    s_mul_hi_u32 s32, s2, 536870913
    s_mul_i32 s33, s32, 8
    s_sub_u32 s33, s2, s33
    s_lshl_b32 s40, s32, 6
    s_mul_i32 s41, s33, 216
    v_lshrrev_b32 v1, 6, v0
    v_and_b32 v2, 63, v0
    v_readfirstlane_b32 s42, v1
    v_lshrrev_b32 v8, 3, v2
    v_and_b32 v9, 7, v2
    v_xor_b32 v9, v9, v8
    s_lshl_b32 s43, s42, 4
    s_add_u32 s43, s43, s40
    v_add_u32 v10, s43, v8
    s_mov_b32 s45, 1280
    v_mul_lo_u32 v10, v10, s45
    v_lshl_add_u32 v10, v9, 4, v10
    v_add_u32 v11, 10240, v10
    s_mov_b32 s46, 3456
    s_mov_b32 s48, 153391690
    s_lshl_b32 s47, s41, 1
    s_mul_i32 s44, s42, 448
    v_add_u32 v50, s44, v2
    v_mul_hi_u32 v51, v50, s48
    v_mul_u32_u24 v52, 28, v51
    v_sub_u32 v52, v50, v52
    v_mul_lo_u32 v53, v51, s46
    v_lshl_add_u32 v53, v52, 4, v53
    v_add_u32 v240, s47, v53
    v_add_u32 v50, s44, v2
    v_add_u32 v50, 64, v50
    v_mul_hi_u32 v51, v50, s48
    v_mul_u32_u24 v52, 28, v51
    v_sub_u32 v52, v50, v52
    v_mul_lo_u32 v53, v51, s46
    v_lshl_add_u32 v53, v52, 4, v53
    v_add_u32 v241, s47, v53
    v_add_u32 v50, s44, v2
    v_add_u32 v50, 128, v50
    v_mul_hi_u32 v51, v50, s48
    v_mul_u32_u24 v52, 28, v51
    v_sub_u32 v52, v50, v52
    v_mul_lo_u32 v53, v51, s46
    v_lshl_add_u32 v53, v52, 4, v53
    v_add_u32 v242, s47, v53
    v_add_u32 v50, s44, v2
    v_add_u32 v50, 192, v50
    v_mul_hi_u32 v51, v50, s48
    v_mul_u32_u24 v52, 28, v51
    v_sub_u32 v52, v50, v52
    v_mul_lo_u32 v53, v51, s46
    v_lshl_add_u32 v53, v52, 4, v53
    v_add_u32 v243, s47, v53
    v_add_u32 v50, s44, v2
    v_add_u32 v50, 256, v50
    v_mul_hi_u32 v51, v50, s48
    v_mul_u32_u24 v52, 28, v51
    v_sub_u32 v52, v50, v52
    v_mul_lo_u32 v53, v51, s46
    v_lshl_add_u32 v53, v52, 4, v53
    v_add_u32 v244, s47, v53
    v_add_u32 v50, s44, v2
    v_add_u32 v50, 320, v50
    v_mul_hi_u32 v51, v50, s48
    v_mul_u32_u24 v52, 28, v51
    v_sub_u32 v52, v50, v52
    v_mul_lo_u32 v53, v51, s46
    v_lshl_add_u32 v53, v52, 4, v53
    v_add_u32 v245, s47, v53
    v_add_u32 v50, s44, v2
    v_add_u32 v50, 384, v50
    v_mul_hi_u32 v51, v50, s48
    v_mul_u32_u24 v52, 28, v51
    v_sub_u32 v52, v50, v52
    v_mul_lo_u32 v53, v51, s46
    v_lshl_add_u32 v53, v52, 4, v53
    v_add_u32 v246, s47, v53
    s_waitcnt lgkmcnt(0)
    s_add_u32 s8, s4, 16777216
    s_addc_u32 s9, s5, 0
    s_and_b32 s9, s9, 0xffff
    s_mov_b32 s10, 2621440
    s_mov_b32 s11, 0x00020000
    s_mov_b32 s12, s6
    s_mov_b32 s13, s7
    s_and_b32 s13, s13, 0xffff
    s_mov_b32 s14, 2211840
    s_mov_b32 s15, 0x00020000
    s_mov_b32 s49, 0
    s_mov_b32 s50, 0
    s_mov_b32 s60, 0
    s_mov_b32 s62, 0
    s_mov_b32 s63, 0
    s_lshl_b32 s64, s42, 11
    s_mul_i32 s65, s42, 7168
    s_add_u32 s65, s65, 8192
    s_lshr_b32 s53, s42, 1
    s_and_b32 s54, s42, 1
    v_and_b32 v3, 15, v2
    v_lshrrev_b32 v4, 4, v2
    s_mul_i32 s55, s53, 32
    s_add_u32 s55, s55, s40
    v_add_u32 v5, s55, v3
    s_mul_i32 s56, s54, 112
    s_add_u32 s56, s56, s41
    v_lshl_add_u32 v6, v4, 2, s56
    s_mov_b32 s44, 3456
    v_mul_lo_u32 v7, v5, s44
    v_lshl_add_u32 v7, v6, 1, v7
    v_add_u32 v16, 55296, v7
    s_cmp_lt_u32 s60, 10
    s_cselect_b32 s61, s62, 0x7ffffff0
    s_add_u32 s60, s60, 1
    s_add_u32 s62, s62, 128
    s_add_u32 m0, s63, s64
    s_nop 0
    buffer_load_dwordx4 v10, s[8:11], s61 offen lds
    s_add_u32 m0, m0, 1024
    s_nop 0
    buffer_load_dwordx4 v11, s[8:11], s61 offen lds
    s_add_u32 m0, s63, s65
    s_nop 0
    buffer_load_dwordx4 v240, s[12:15], s49 offen lds
    s_add_u32 m0, m0, 1024
    s_nop 0
    buffer_load_dwordx4 v241, s[12:15], s49 offen lds
    s_add_u32 m0, m0, 1024
    s_nop 0
    buffer_load_dwordx4 v242, s[12:15], s49 offen lds
    s_add_u32 m0, m0, 1024
    s_nop 0
    buffer_load_dwordx4 v243, s[12:15], s49 offen lds
    s_add_u32 m0, m0, 1024
    s_nop 0
    buffer_load_dwordx4 v244, s[12:15], s49 offen lds
    s_add_u32 m0, m0, 1024
    s_nop 0
    buffer_load_dwordx4 v245, s[12:15], s49 offen lds
    s_add_u32 m0, m0, 1024
    s_nop 0
    buffer_load_dwordx4 v246, s[12:15], s49 offen lds
    s_add_u32 s49, s49, 221184
    s_add_u32 s63, s63, 36864
    s_cmp_eq_u32 s63, 147456
    s_cselect_b32 s63, 0, s63
    s_cmp_lt_u32 s60, 10
    s_cselect_b32 s61, s62, 0x7ffffff0
    s_add_u32 s60, s60, 1
    s_add_u32 s62, s62, 128
    s_add_u32 m0, s63, s64
    s_nop 0
    buffer_load_dwordx4 v10, s[8:11], s61 offen lds
    s_add_u32 m0, m0, 1024
    s_nop 0
    buffer_load_dwordx4 v11, s[8:11], s61 offen lds
    s_add_u32 m0, s63, s65
    s_nop 0
    buffer_load_dwordx4 v240, s[12:15], s49 offen lds
    s_add_u32 m0, m0, 1024
    s_nop 0
    buffer_load_dwordx4 v241, s[12:15], s49 offen lds
    s_add_u32 m0, m0, 1024
    s_nop 0
    buffer_load_dwordx4 v242, s[12:15], s49 offen lds
    s_add_u32 m0, m0, 1024
    s_nop 0
    buffer_load_dwordx4 v243, s[12:15], s49 offen lds
    s_add_u32 m0, m0, 1024
    s_nop 0
    buffer_load_dwordx4 v244, s[12:15], s49 offen lds
    s_add_u32 m0, m0, 1024
    s_nop 0
    buffer_load_dwordx4 v245, s[12:15], s49 offen lds
    s_add_u32 m0, m0, 1024
    s_nop 0
    buffer_load_dwordx4 v246, s[12:15], s49 offen lds
    s_add_u32 s49, s49, 221184
    s_add_u32 s63, s63, 36864
    s_cmp_eq_u32 s63, 147456
    s_cselect_b32 s63, 0, s63
    s_cmp_lt_u32 s60, 10
    s_cselect_b32 s61, s62, 0x7ffffff0
    s_add_u32 s60, s60, 1
    s_add_u32 s62, s62, 128
    s_add_u32 m0, s63, s64
    s_nop 0
    buffer_load_dwordx4 v10, s[8:11], s61 offen lds
    s_add_u32 m0, m0, 1024
    s_nop 0
    buffer_load_dwordx4 v11, s[8:11], s61 offen lds
    s_add_u32 m0, s63, s65
    s_nop 0
    buffer_load_dwordx4 v240, s[12:15], s49 offen lds
    s_add_u32 m0, m0, 1024
    s_nop 0
    buffer_load_dwordx4 v241, s[12:15], s49 offen lds
    s_add_u32 m0, m0, 1024
    s_nop 0
    buffer_load_dwordx4 v242, s[12:15], s49 offen lds
    s_add_u32 m0, m0, 1024
    s_nop 0
    buffer_load_dwordx4 v243, s[12:15], s49 offen lds
    s_add_u32 m0, m0, 1024
    s_nop 0
    buffer_load_dwordx4 v244, s[12:15], s49 offen lds
    s_add_u32 m0, m0, 1024
    s_nop 0
    buffer_load_dwordx4 v245, s[12:15], s49 offen lds
    s_add_u32 m0, m0, 1024
    s_nop 0
    buffer_load_dwordx4 v246, s[12:15], s49 offen lds
    s_add_u32 s49, s49, 221184
    s_add_u32 s63, s63, 36864
    s_cmp_eq_u32 s63, 147456
    s_cselect_b32 s63, 0, s63
    s_lshr_b32 s53, s42, 1
    s_and_b32 s54, s42, 1
    v_and_b32 v3, 15, v2
    v_lshrrev_b32 v4, 4, v2
    v_and_b32 v22, 7, v3
    v_xor_b32 v22, v22, v4
    v_lshlrev_b32 v22, 4, v22
    v_lshl_add_u32 v22, v3, 7, v22
    s_mul_i32 s55, s53, 4096
    v_add_u32 v22, s55, v22
    v_xor_b32 v23, 64, v22
    v_lshrrev_b32 v24, 2, v3
    v_lshl_add_u32 v24, v4, 3, v24
    v_mul_u32_u24 v24, 448, v24
    v_and_b32 v25, 3, v2
    v_lshl_add_u32 v24, v25, 3, v24
    s_mul_i32 s55, s54, 224
    s_add_u32 s55, s55, 8192
    v_add_u32 v24, s55, v24
    v_mov_b32 v72, 0
    v_mov_b32 v73, 0
    v_mov_b32 v74, 0
    v_mov_b32 v75, 0
    v_mov_b32 v76, 0
    v_mov_b32 v77, 0
    v_mov_b32 v78, 0
    v_mov_b32 v79, 0
    v_mov_b32 v80, 0
    v_mov_b32 v81, 0
    v_mov_b32 v82, 0
    v_mov_b32 v83, 0
    v_mov_b32 v84, 0
    v_mov_b32 v85, 0
    v_mov_b32 v86, 0
    v_mov_b32 v87, 0
    v_mov_b32 v88, 0
    v_mov_b32 v89, 0
    v_mov_b32 v90, 0
    v_mov_b32 v91, 0
    v_mov_b32 v92, 0
    v_mov_b32 v93, 0
    v_mov_b32 v94, 0
    v_mov_b32 v95, 0
    v_mov_b32 v96, 0
    v_mov_b32 v97, 0
    v_mov_b32 v98, 0
    v_mov_b32 v99, 0
    v_mov_b32 v100, 0
    v_mov_b32 v101, 0
    v_mov_b32 v102, 0
    v_mov_b32 v103, 0
    v_mov_b32 v104, 0
    v_mov_b32 v105, 0
    v_mov_b32 v106, 0
    v_mov_b32 v107, 0
    v_mov_b32 v108, 0
    v_mov_b32 v109, 0
    v_mov_b32 v110, 0
    v_mov_b32 v111, 0
    v_mov_b32 v112, 0
    v_mov_b32 v113, 0
    v_mov_b32 v114, 0
    v_mov_b32 v115, 0
    v_mov_b32 v116, 0
    v_mov_b32 v117, 0
    v_mov_b32 v118, 0
    v_mov_b32 v119, 0
    v_mov_b32 v120, 0
    v_mov_b32 v121, 0
    v_mov_b32 v122, 0
    v_mov_b32 v123, 0
    v_mov_b32 v124, 0
    v_mov_b32 v125, 0
    v_mov_b32 v126, 0
    v_mov_b32 v127, 0
    v_mov_b32 v60, 0
    v_mov_b32 v62, 0
    v_mov_b32 v61, 0
    v_mov_b32 v63, 0
    v_mov_b32 v64, 0x3f803f80
    v_mov_b32 v40, 0
    v_mov_b32 v41, 0
    v_mov_b32 v42, 0
    v_mov_b32 v43, 0
    v_mov_b32 v44, 0
    v_mov_b32 v45, 0
    v_mov_b32 v46, 0
    s_mov_b32 s66, 0
    s_mov_b32 s51, 10
k6_w3_kernel_loop:
    s_waitcnt vmcnt(18)
    s_barrier
    v_add_u32 v26, s66, v22
    v_add_u32 v27, s66, v23
    v_add_u32 v28, s66, v24
    ds_read_b128 v[128:131], v26 offset:0
    ds_read_b128 v[132:135], v26 offset:2048
    ds_read_b64_tr_b16 v[136:137], v28 offset:0
    ds_read_b64_tr_b16 v[138:139], v28 offset:1792
    ds_read_b64_tr_b16 v[140:141], v28 offset:32
    ds_read_b64_tr_b16 v[142:143], v28 offset:1824
    ds_read_b64_tr_b16 v[144:145], v28 offset:64
    ds_read_b64_tr_b16 v[146:147], v28 offset:1856
    ds_read_b64_tr_b16 v[148:149], v28 offset:96
    ds_read_b64_tr_b16 v[150:151], v28 offset:1888
    ds_read_b64_tr_b16 v[152:153], v28 offset:128
    ds_read_b64_tr_b16 v[154:155], v28 offset:1920
    ds_read_b64_tr_b16 v[156:157], v28 offset:160
    ds_read_b64_tr_b16 v[158:159], v28 offset:1952
    ds_read_b64_tr_b16 v[160:161], v28 offset:192
    ds_read_b64_tr_b16 v[162:163], v28 offset:1984
    ds_read_b128 v[164:167], v27 offset:0
    ds_read_b128 v[168:171], v27 offset:2048
    ds_read_b64_tr_b16 v[172:173], v28 offset:14336
    ds_read_b64_tr_b16 v[174:175], v28 offset:16128
    ds_read_b64_tr_b16 v[176:177], v28 offset:14368
    ds_read_b64_tr_b16 v[178:179], v28 offset:16160
    ds_read_b64_tr_b16 v[180:181], v28 offset:14400
    ds_read_b64_tr_b16 v[182:183], v28 offset:16192
    ds_read_b64_tr_b16 v[184:185], v28 offset:14432
    ds_read_b64_tr_b16 v[186:187], v28 offset:16224
    ds_read_b64_tr_b16 v[188:189], v28 offset:14464
    ds_read_b64_tr_b16 v[190:191], v28 offset:16256
    ds_read_b64_tr_b16 v[192:193], v28 offset:14496
    ds_read_b64_tr_b16 v[194:195], v28 offset:16288
    ds_read_b64_tr_b16 v[196:197], v28 offset:14528
    ds_read_b64_tr_b16 v[198:199], v28 offset:16320
    s_cmp_lt_u32 s60, 10
    s_cselect_b32 s61, s62, 0x7ffffff0
    s_add_u32 s60, s60, 1
    s_add_u32 s62, s62, 128
    s_add_u32 m0, s63, s64
    s_nop 0
    buffer_load_dwordx4 v10, s[8:11], s61 offen lds
    s_add_u32 m0, m0, 1024
    s_nop 0
    buffer_load_dwordx4 v11, s[8:11], s61 offen lds
    s_add_u32 m0, s63, s65
    s_nop 0
    buffer_load_dwordx4 v240, s[12:15], s49 offen lds
    s_add_u32 m0, m0, 1024
    s_nop 0
    buffer_load_dwordx4 v241, s[12:15], s49 offen lds
    s_add_u32 m0, m0, 1024
    s_nop 0
    buffer_load_dwordx4 v242, s[12:15], s49 offen lds
    s_add_u32 m0, m0, 1024
    s_nop 0
    buffer_load_dwordx4 v243, s[12:15], s49 offen lds
    s_add_u32 m0, m0, 1024
    s_nop 0
    buffer_load_dwordx4 v244, s[12:15], s49 offen lds
    s_add_u32 m0, m0, 1024
    s_nop 0
    buffer_load_dwordx4 v245, s[12:15], s49 offen lds
    s_add_u32 m0, m0, 1024
    s_nop 0
    buffer_load_dwordx4 v246, s[12:15], s49 offen lds
    s_add_u32 s49, s49, 221184
    s_add_u32 s63, s63, 36864
    s_cmp_eq_u32 s63, 147456
    s_cselect_b32 s63, 0, s63
    s_waitcnt lgkmcnt(15)
    v_mfma_f32_16x16x32_bf16 v[72:75], v[136:139], v[128:131], v[72:75]
    v_mfma_f32_16x16x32_bf16 v[76:79], v[136:139], v[132:135], v[76:79]
    v_mfma_f32_16x16x32_bf16 v[80:83], v[140:143], v[128:131], v[80:83]
    v_mfma_f32_16x16x32_bf16 v[84:87], v[140:143], v[132:135], v[84:87]
    v_mfma_f32_16x16x32_bf16 v[88:91], v[144:147], v[128:131], v[88:91]
    v_mfma_f32_16x16x32_bf16 v[92:95], v[144:147], v[132:135], v[92:95]
    v_mfma_f32_16x16x32_bf16 v[96:99], v[148:151], v[128:131], v[96:99]
    v_mfma_f32_16x16x32_bf16 v[100:103], v[148:151], v[132:135], v[100:103]
    v_mfma_f32_16x16x32_bf16 v[104:107], v[152:155], v[128:131], v[104:107]
    v_mfma_f32_16x16x32_bf16 v[108:111], v[152:155], v[132:135], v[108:111]
    v_mfma_f32_16x16x32_bf16 v[112:115], v[156:159], v[128:131], v[112:115]
    v_mfma_f32_16x16x32_bf16 v[116:119], v[156:159], v[132:135], v[116:119]
    v_mfma_f32_16x16x32_bf16 v[120:123], v[160:163], v[128:131], v[120:123]
    v_mfma_f32_16x16x32_bf16 v[124:127], v[160:163], v[132:135], v[124:127]
    v_dot2_f32_bf16 v60, v128, v64, v60
    v_dot2_f32_bf16 v62, v128, v128, v62
    v_dot2_f32_bf16 v60, v129, v64, v60
    v_dot2_f32_bf16 v62, v129, v129, v62
    v_dot2_f32_bf16 v60, v130, v64, v60
    v_dot2_f32_bf16 v62, v130, v130, v62
    v_dot2_f32_bf16 v60, v131, v64, v60
    v_dot2_f32_bf16 v62, v131, v131, v62
    v_dot2_f32_bf16 v61, v132, v64, v61
    v_dot2_f32_bf16 v63, v132, v132, v63
    v_dot2_f32_bf16 v61, v133, v64, v61
    v_dot2_f32_bf16 v63, v133, v133, v63
    v_dot2_f32_bf16 v61, v134, v64, v61
    v_dot2_f32_bf16 v63, v134, v134, v63
    v_dot2_f32_bf16 v61, v135, v64, v61
    v_dot2_f32_bf16 v63, v135, v135, v63
    v_dot2_f32_bf16 v40, v136, v64, v40
    v_dot2_f32_bf16 v40, v137, v64, v40
    v_dot2_f32_bf16 v40, v138, v64, v40
    v_dot2_f32_bf16 v40, v139, v64, v40
    v_dot2_f32_bf16 v41, v140, v64, v41
    v_dot2_f32_bf16 v41, v141, v64, v41
    v_dot2_f32_bf16 v41, v142, v64, v41
    v_dot2_f32_bf16 v41, v143, v64, v41
    v_dot2_f32_bf16 v42, v144, v64, v42
    v_dot2_f32_bf16 v42, v145, v64, v42
    v_dot2_f32_bf16 v42, v146, v64, v42
    v_dot2_f32_bf16 v42, v147, v64, v42
    v_dot2_f32_bf16 v43, v148, v64, v43
    v_dot2_f32_bf16 v43, v149, v64, v43
    v_dot2_f32_bf16 v43, v150, v64, v43
    v_dot2_f32_bf16 v43, v151, v64, v43
    v_dot2_f32_bf16 v44, v152, v64, v44
    v_dot2_f32_bf16 v44, v153, v64, v44
    v_dot2_f32_bf16 v44, v154, v64, v44
    v_dot2_f32_bf16 v44, v155, v64, v44
    v_dot2_f32_bf16 v45, v156, v64, v45
    v_dot2_f32_bf16 v45, v157, v64, v45
    v_dot2_f32_bf16 v45, v158, v64, v45
    v_dot2_f32_bf16 v45, v159, v64, v45
    v_dot2_f32_bf16 v46, v160, v64, v46
    v_dot2_f32_bf16 v46, v161, v64, v46
    v_dot2_f32_bf16 v46, v162, v64, v46
    v_dot2_f32_bf16 v46, v163, v64, v46
    s_waitcnt lgkmcnt(0)
    v_mfma_f32_16x16x32_bf16 v[72:75], v[172:175], v[164:167], v[72:75]
    v_mfma_f32_16x16x32_bf16 v[76:79], v[172:175], v[168:171], v[76:79]
    v_mfma_f32_16x16x32_bf16 v[80:83], v[176:179], v[164:167], v[80:83]
    v_mfma_f32_16x16x32_bf16 v[84:87], v[176:179], v[168:171], v[84:87]
    v_mfma_f32_16x16x32_bf16 v[88:91], v[180:183], v[164:167], v[88:91]
    v_mfma_f32_16x16x32_bf16 v[92:95], v[180:183], v[168:171], v[92:95]
    v_mfma_f32_16x16x32_bf16 v[96:99], v[184:187], v[164:167], v[96:99]
    v_mfma_f32_16x16x32_bf16 v[100:103], v[184:187], v[168:171], v[100:103]
    v_mfma_f32_16x16x32_bf16 v[104:107], v[188:191], v[164:167], v[104:107]
    v_mfma_f32_16x16x32_bf16 v[108:111], v[188:191], v[168:171], v[108:111]
    v_mfma_f32_16x16x32_bf16 v[112:115], v[192:195], v[164:167], v[112:115]
    v_mfma_f32_16x16x32_bf16 v[116:119], v[192:195], v[168:171], v[116:119]
    v_mfma_f32_16x16x32_bf16 v[120:123], v[196:199], v[164:167], v[120:123]
    v_mfma_f32_16x16x32_bf16 v[124:127], v[196:199], v[168:171], v[124:127]
    v_dot2_f32_bf16 v60, v164, v64, v60
    v_dot2_f32_bf16 v62, v164, v164, v62
    v_dot2_f32_bf16 v60, v165, v64, v60
    v_dot2_f32_bf16 v62, v165, v165, v62
    v_dot2_f32_bf16 v60, v166, v64, v60
    v_dot2_f32_bf16 v62, v166, v166, v62
    v_dot2_f32_bf16 v60, v167, v64, v60
    v_dot2_f32_bf16 v62, v167, v167, v62
    v_dot2_f32_bf16 v61, v168, v64, v61
    v_dot2_f32_bf16 v63, v168, v168, v63
    v_dot2_f32_bf16 v61, v169, v64, v61
    v_dot2_f32_bf16 v63, v169, v169, v63
    v_dot2_f32_bf16 v61, v170, v64, v61
    v_dot2_f32_bf16 v63, v170, v170, v63
    v_dot2_f32_bf16 v61, v171, v64, v61
    v_dot2_f32_bf16 v63, v171, v171, v63
    v_dot2_f32_bf16 v40, v172, v64, v40
    v_dot2_f32_bf16 v40, v173, v64, v40
    v_dot2_f32_bf16 v40, v174, v64, v40
    v_dot2_f32_bf16 v40, v175, v64, v40
    v_dot2_f32_bf16 v41, v176, v64, v41
    v_dot2_f32_bf16 v41, v177, v64, v41
    v_dot2_f32_bf16 v41, v178, v64, v41
    v_dot2_f32_bf16 v41, v179, v64, v41
    v_dot2_f32_bf16 v42, v180, v64, v42
    v_dot2_f32_bf16 v42, v181, v64, v42
    v_dot2_f32_bf16 v42, v182, v64, v42
    v_dot2_f32_bf16 v42, v183, v64, v42
    v_dot2_f32_bf16 v43, v184, v64, v43
    v_dot2_f32_bf16 v43, v185, v64, v43
    v_dot2_f32_bf16 v43, v186, v64, v43
    v_dot2_f32_bf16 v43, v187, v64, v43
    v_dot2_f32_bf16 v44, v188, v64, v44
    v_dot2_f32_bf16 v44, v189, v64, v44
    v_dot2_f32_bf16 v44, v190, v64, v44
    v_dot2_f32_bf16 v44, v191, v64, v44
    v_dot2_f32_bf16 v45, v192, v64, v45
    v_dot2_f32_bf16 v45, v193, v64, v45
    v_dot2_f32_bf16 v45, v194, v64, v45
    v_dot2_f32_bf16 v45, v195, v64, v45
    v_dot2_f32_bf16 v46, v196, v64, v46
    v_dot2_f32_bf16 v46, v197, v64, v46
    v_dot2_f32_bf16 v46, v198, v64, v46
    v_dot2_f32_bf16 v46, v199, v64, v46
    s_add_u32 s66, s66, 36864
    s_cmp_eq_u32 s66, 147456
    s_cselect_b32 s66, 0, s66
    s_sub_u32 s51, s51, 1
    s_cmp_lg_u32 s51, 0
    s_cbranch_scc1 k6_w3_kernel_loop
    s_waitcnt vmcnt(0)
    s_barrier
    s_nop 7
    ds_swizzle_b32 v136, v60 offset:0x401F
    ds_swizzle_b32 v137, v61 offset:0x401F
    ds_swizzle_b32 v138, v62 offset:0x401F
    ds_swizzle_b32 v139, v63 offset:0x401F
    ds_swizzle_b32 v140, v40 offset:0x401F
    ds_swizzle_b32 v141, v41 offset:0x401F
    ds_swizzle_b32 v142, v42 offset:0x401F
    ds_swizzle_b32 v143, v43 offset:0x401F
    ds_swizzle_b32 v144, v44 offset:0x401F
    ds_swizzle_b32 v145, v45 offset:0x401F
    ds_swizzle_b32 v146, v46 offset:0x401F
    s_waitcnt lgkmcnt(0)
    v_add_f32 v60, v60, v136
    v_mov_b32 v136, v60
    v_add_f32 v61, v61, v137
    v_mov_b32 v137, v61
    v_add_f32 v62, v62, v138
    v_mov_b32 v138, v62
    v_add_f32 v63, v63, v139
    v_mov_b32 v139, v63
    v_add_f32 v40, v40, v140
    v_mov_b32 v140, v40
    v_add_f32 v41, v41, v141
    v_mov_b32 v141, v41
    v_add_f32 v42, v42, v142
    v_mov_b32 v142, v42
    v_add_f32 v43, v43, v143
    v_mov_b32 v143, v43
    v_add_f32 v44, v44, v144
    v_mov_b32 v144, v44
    v_add_f32 v45, v45, v145
    v_mov_b32 v145, v45
    v_add_f32 v46, v46, v146
    v_mov_b32 v146, v46
    s_nop 1
    v_permlane32_swap_b32 v60, v136
    v_permlane32_swap_b32 v61, v137
    v_permlane32_swap_b32 v62, v138
    v_permlane32_swap_b32 v63, v139
    v_permlane32_swap_b32 v40, v140
    v_permlane32_swap_b32 v41, v141
    v_permlane32_swap_b32 v42, v142
    v_permlane32_swap_b32 v43, v143
    v_permlane32_swap_b32 v44, v144
    v_permlane32_swap_b32 v45, v145
    v_permlane32_swap_b32 v46, v146
    s_nop 1
    v_add_f32 v60, v60, v136
    v_add_f32 v61, v61, v137
    v_add_f32 v62, v62, v138
    v_add_f32 v63, v63, v139
    v_add_f32 v40, v40, v140
    v_add_f32 v41, v41, v141
    v_add_f32 v42, v42, v142
    v_add_f32 v43, v43, v143
    v_add_f32 v44, v44, v144
    v_add_f32 v45, v45, v145
    v_add_f32 v46, v46, v146
    s_mul_i32 s57, s42, 448
    v_lshl_add_u32 v50, v3, 2, s57
    v_lshl_add_u32 v51, v4, 4, s57
    ds_write_b32 v50, v40 offset:0
    ds_write_b32 v50, v41 offset:64
    ds_write_b32 v50, v42 offset:128
    ds_write_b32 v50, v43 offset:192
    ds_write_b32 v50, v44 offset:256
    ds_write_b32 v50, v45 offset:320
    ds_write_b32 v50, v46 offset:384
    v_mul_f32 v60, 0x3acccccd, v60
    v_mul_f32 v62, 0x3acccccd, v62
    v_fma_f32 v62, -v60, v60, v62
    v_add_f32 v50, 0x3727c5ac, v62
    v_rsq_f32 v66, v50
    s_nop 0
    v_mov_b32 v62, v66
    v_mul_f32 v61, 0x3acccccd, v61
    v_mul_f32 v63, 0x3acccccd, v63
    v_fma_f32 v63, -v61, v61, v63
    v_add_f32 v50, 0x3727c5ac, v63
    v_rsq_f32 v67, v50
    s_nop 0
    v_mov_b32 v63, v67
    s_waitcnt lgkmcnt(0)
    ds_read_b128 v[128:131], v51 offset:0
    ds_read_b128 v[132:135], v51 offset:64
    ds_read_b128 v[136:139], v51 offset:128
    ds_read_b128 v[140:143], v51 offset:192
    ds_read_b128 v[144:147], v51 offset:256
    ds_read_b128 v[148:151], v51 offset:320
    ds_read_b128 v[152:155], v51 offset:384
    s_waitcnt lgkmcnt(0)
    v_fma_f32 v72, -v60, v128, v72
    v_mul_f32 v72, v72, v62
    v_fma_f32 v73, -v60, v129, v73
    v_mul_f32 v73, v73, v62
    v_fma_f32 v74, -v60, v130, v74
    v_mul_f32 v74, v74, v62
    v_fma_f32 v75, -v60, v131, v75
    v_mul_f32 v75, v75, v62
    v_fma_f32 v76, -v61, v128, v76
    v_mul_f32 v76, v76, v63
    v_fma_f32 v77, -v61, v129, v77
    v_mul_f32 v77, v77, v63
    v_fma_f32 v78, -v61, v130, v78
    v_mul_f32 v78, v78, v63
    v_fma_f32 v79, -v61, v131, v79
    v_mul_f32 v79, v79, v63
    v_fma_f32 v80, -v60, v132, v80
    v_mul_f32 v80, v80, v62
    v_fma_f32 v81, -v60, v133, v81
    v_mul_f32 v81, v81, v62
    v_fma_f32 v82, -v60, v134, v82
    v_mul_f32 v82, v82, v62
    v_fma_f32 v83, -v60, v135, v83
    v_mul_f32 v83, v83, v62
    v_fma_f32 v84, -v61, v132, v84
    v_mul_f32 v84, v84, v63
    v_fma_f32 v85, -v61, v133, v85
    v_mul_f32 v85, v85, v63
    v_fma_f32 v86, -v61, v134, v86
    v_mul_f32 v86, v86, v63
    v_fma_f32 v87, -v61, v135, v87
    v_mul_f32 v87, v87, v63
    v_fma_f32 v88, -v60, v136, v88
    v_mul_f32 v88, v88, v62
    v_fma_f32 v89, -v60, v137, v89
    v_mul_f32 v89, v89, v62
    v_fma_f32 v90, -v60, v138, v90
    v_mul_f32 v90, v90, v62
    v_fma_f32 v91, -v60, v139, v91
    v_mul_f32 v91, v91, v62
    v_fma_f32 v92, -v61, v136, v92
    v_mul_f32 v92, v92, v63
    v_fma_f32 v93, -v61, v137, v93
    v_mul_f32 v93, v93, v63
    v_fma_f32 v94, -v61, v138, v94
    v_mul_f32 v94, v94, v63
    v_fma_f32 v95, -v61, v139, v95
    v_mul_f32 v95, v95, v63
    v_fma_f32 v96, -v60, v140, v96
    v_mul_f32 v96, v96, v62
    v_fma_f32 v97, -v60, v141, v97
    v_mul_f32 v97, v97, v62
    v_fma_f32 v98, -v60, v142, v98
    v_mul_f32 v98, v98, v62
    v_fma_f32 v99, -v60, v143, v99
    v_mul_f32 v99, v99, v62
    v_fma_f32 v100, -v61, v140, v100
    v_mul_f32 v100, v100, v63
    v_fma_f32 v101, -v61, v141, v101
    v_mul_f32 v101, v101, v63
    v_fma_f32 v102, -v61, v142, v102
    v_mul_f32 v102, v102, v63
    v_fma_f32 v103, -v61, v143, v103
    v_mul_f32 v103, v103, v63
    v_fma_f32 v104, -v60, v144, v104
    v_mul_f32 v104, v104, v62
    v_fma_f32 v105, -v60, v145, v105
    v_mul_f32 v105, v105, v62
    v_fma_f32 v106, -v60, v146, v106
    v_mul_f32 v106, v106, v62
    v_fma_f32 v107, -v60, v147, v107
    v_mul_f32 v107, v107, v62
    v_fma_f32 v108, -v61, v144, v108
    v_mul_f32 v108, v108, v63
    v_fma_f32 v109, -v61, v145, v109
    v_mul_f32 v109, v109, v63
    v_fma_f32 v110, -v61, v146, v110
    v_mul_f32 v110, v110, v63
    v_fma_f32 v111, -v61, v147, v111
    v_mul_f32 v111, v111, v63
    v_fma_f32 v112, -v60, v148, v112
    v_mul_f32 v112, v112, v62
    v_fma_f32 v113, -v60, v149, v113
    v_mul_f32 v113, v113, v62
    v_fma_f32 v114, -v60, v150, v114
    v_mul_f32 v114, v114, v62
    v_fma_f32 v115, -v60, v151, v115
    v_mul_f32 v115, v115, v62
    v_fma_f32 v116, -v61, v148, v116
    v_mul_f32 v116, v116, v63
    v_fma_f32 v117, -v61, v149, v117
    v_mul_f32 v117, v117, v63
    v_fma_f32 v118, -v61, v150, v118
    v_mul_f32 v118, v118, v63
    v_fma_f32 v119, -v61, v151, v119
    v_mul_f32 v119, v119, v63
    v_fma_f32 v120, -v60, v152, v120
    v_mul_f32 v120, v120, v62
    v_fma_f32 v121, -v60, v153, v121
    v_mul_f32 v121, v121, v62
    v_fma_f32 v122, -v60, v154, v122
    v_mul_f32 v122, v122, v62
    v_fma_f32 v123, -v60, v155, v123
    v_mul_f32 v123, v123, v62
    v_fma_f32 v124, -v61, v152, v124
    v_mul_f32 v124, v124, v63
    v_fma_f32 v125, -v61, v153, v125
    v_mul_f32 v125, v125, v63
    v_fma_f32 v126, -v61, v154, v126
    v_mul_f32 v126, v126, v63
    v_fma_f32 v127, -v61, v155, v127
    v_mul_f32 v127, v127, v63
    s_waitcnt vmcnt(0)
    s_add_u32 s16, s4, 19922944
    s_addc_u32 s17, s5, 0
    s_and_b32 s17, s17, 0xffff
    s_mov_b32 s18, 7077888
    s_mov_b32 s19, 0x00020000
    v_mov_b32 v58, 0x3d372713
    s_mov_b32 s70, 0
k6_w3_kernel_gl:
    s_set_gpr_idx_on s70, gpr_idx(SRC0)
    v_mov_b32 v50, v72
    v_mov_b32 v51, v73
    v_mov_b32 v52, v74
    v_mov_b32 v53, v75
    s_set_gpr_idx_off
    v_mul_f32 v54, v50, v50
    v_mul_f32 v55, v51, v51
    v_mul_f32 v56, v52, v52
    v_mul_f32 v57, v53, v53
    v_fma_f32 v54, v54, v58, 1.0
    v_fma_f32 v55, v55, v58, 1.0
    v_fma_f32 v56, v56, v58, 1.0
    v_fma_f32 v57, v57, v58, 1.0
    v_mul_f32 v54, v54, v50
    v_mul_f32 v55, v55, v51
    v_mul_f32 v56, v56, v52
    v_mul_f32 v57, v57, v53
    v_mul_f32 v54, 0xc0135761, v54
    v_mul_f32 v55, 0xc0135761, v55
    v_mul_f32 v56, 0xc0135761, v56
    v_mul_f32 v57, 0xc0135761, v57
    v_exp_f32 v54, v54
    v_exp_f32 v55, v55
    v_exp_f32 v56, v56
    v_exp_f32 v57, v57
    s_nop 0
    v_add_f32 v54, 1.0, v54
    v_add_f32 v55, 1.0, v55
    v_add_f32 v56, 1.0, v56
    v_add_f32 v57, 1.0, v57
    v_rcp_f32 v54, v54
    v_rcp_f32 v55, v55
    v_rcp_f32 v56, v56
    v_rcp_f32 v57, v57
    s_nop 0
    v_mul_f32 v50, v50, v54
    v_mul_f32 v51, v51, v55
    v_mul_f32 v52, v52, v56
    v_mul_f32 v53, v53, v57
    s_set_gpr_idx_on s70, gpr_idx(DST)
    v_mov_b32 v72, v50
    v_mov_b32 v73, v51
    v_mov_b32 v74, v52
    v_mov_b32 v75, v53
    s_set_gpr_idx_off
    s_add_u32 s70, s70, 4
    s_cmp_lt_u32 s70, 56
    s_cbranch_scc1 k6_w3_kernel_gl
    v_cvt_pk_bf16_f32 v50, v72, v73
    v_cvt_pk_bf16_f32 v51, v74, v75
    buffer_store_dwordx2 v[50:51], v7, s[16:19], 0 offen offset:0
    v_cvt_pk_bf16_f32 v50, v76, v77
    v_cvt_pk_bf16_f32 v51, v78, v79
    buffer_store_dwordx2 v[50:51], v16, s[16:19], 0 offen offset:0
    v_cvt_pk_bf16_f32 v50, v80, v81
    v_cvt_pk_bf16_f32 v51, v82, v83
    buffer_store_dwordx2 v[50:51], v7, s[16:19], 0 offen offset:32
    v_cvt_pk_bf16_f32 v50, v84, v85
    v_cvt_pk_bf16_f32 v51, v86, v87
    buffer_store_dwordx2 v[50:51], v16, s[16:19], 0 offen offset:32
    v_cvt_pk_bf16_f32 v50, v88, v89
    v_cvt_pk_bf16_f32 v51, v90, v91
    buffer_store_dwordx2 v[50:51], v7, s[16:19], 0 offen offset:64
    v_cvt_pk_bf16_f32 v50, v92, v93
    v_cvt_pk_bf16_f32 v51, v94, v95
    buffer_store_dwordx2 v[50:51], v16, s[16:19], 0 offen offset:64
    v_cvt_pk_bf16_f32 v50, v96, v97
    v_cvt_pk_bf16_f32 v51, v98, v99
    buffer_store_dwordx2 v[50:51], v7, s[16:19], 0 offen offset:96
    v_cvt_pk_bf16_f32 v50, v100, v101
    v_cvt_pk_bf16_f32 v51, v102, v103
    buffer_store_dwordx2 v[50:51], v16, s[16:19], 0 offen offset:96
    v_cvt_pk_bf16_f32 v50, v104, v105
    v_cvt_pk_bf16_f32 v51, v106, v107
    buffer_store_dwordx2 v[50:51], v7, s[16:19], 0 offen offset:128
    v_cvt_pk_bf16_f32 v50, v108, v109
    v_cvt_pk_bf16_f32 v51, v110, v111
    buffer_store_dwordx2 v[50:51], v16, s[16:19], 0 offen offset:128
    v_cvt_pk_bf16_f32 v50, v112, v113
    v_cvt_pk_bf16_f32 v51, v114, v115
    buffer_store_dwordx2 v[50:51], v7, s[16:19], 0 offen offset:160
    v_cvt_pk_bf16_f32 v50, v116, v117
    v_cvt_pk_bf16_f32 v51, v118, v119
    buffer_store_dwordx2 v[50:51], v16, s[16:19], 0 offen offset:160
    v_cvt_pk_bf16_f32 v50, v120, v121
    v_cvt_pk_bf16_f32 v51, v122, v123
    v_add_u32 v52, 96, v6
    v_cmp_gt_u32 vcc, 1728, v52
    s_and_saveexec_b64 s[58:59], vcc
    buffer_store_dwordx2 v[50:51], v7, s[16:19], 0 offen offset:192
    s_mov_b64 exec, s[58:59]
    v_cvt_pk_bf16_f32 v50, v124, v125
    v_cvt_pk_bf16_f32 v51, v126, v127
    v_add_u32 v52, 96, v6
    v_cmp_gt_u32 vcc, 1728, v52
    s_and_saveexec_b64 s[58:59], vcc
    buffer_store_dwordx2 v[50:51], v16, s[16:19], 0 offen offset:192
    s_mov_b64 exec, s[58:59]
    s_waitcnt vmcnt(0)
    s_branch k6_w3_kernel_end
k6_w3_kernel_end:
    s_endpgm
.globl k7_w4_kernel
.p2align 8
.type k7_w4_kernel,@function
k7_w4_kernel:
    s_cmp_ge_u32 s2, 256
    s_cbranch_scc1 k7_w4_kernel_end
    s_load_dwordx2 s[4:5], s[0:1], 96
    s_load_dwordx2 s[6:7], s[0:1], 72
    s_load_dwordx2 s[36:37], s[0:1], 80
    s_mul_hi_u32 s32, s2, 536870913
    s_mul_i32 s33, s32, 8
    s_sub_u32 s33, s2, s33
    s_lshl_b32 s40, s32, 6
    s_mul_i32 s41, s33, 80
    v_lshrrev_b32 v1, 6, v0
    v_and_b32 v2, 63, v0
    v_readfirstlane_b32 s42, v1
    v_lshrrev_b32 v8, 3, v2
    v_and_b32 v9, 7, v2
    v_xor_b32 v9, v9, v8
    s_lshl_b32 s43, s42, 4
    s_add_u32 s43, s43, s40
    v_add_u32 v10, s43, v8
    s_mov_b32 s45, 3456
    v_mul_lo_u32 v10, v10, s45
    v_lshl_add_u32 v10, v9, 4, v10
    v_add_u32 v11, 27648, v10
    s_mov_b32 s46, 1280
    s_mov_b32 s48, 429496730
    s_lshl_b32 s47, s41, 1
    s_mul_i32 s44, s42, 192
    v_add_u32 v50, s44, v2
    v_mul_hi_u32 v51, v50, s48
    v_mul_u32_u24 v52, 10, v51
    v_sub_u32 v52, v50, v52
    v_mul_lo_u32 v53, v51, s46
    v_lshl_add_u32 v53, v52, 4, v53
    v_add_u32 v240, s47, v53
    v_mov_b32 v53, 0x7ffffff0
    v_cmp_le_u32 vcc, 640, v50
    s_nop 1
    v_cndmask_b32 v240, v240, v53, vcc
    v_add_u32 v50, s44, v2
    v_add_u32 v50, 64, v50
    v_mul_hi_u32 v51, v50, s48
    v_mul_u32_u24 v52, 10, v51
    v_sub_u32 v52, v50, v52
    v_mul_lo_u32 v53, v51, s46
    v_lshl_add_u32 v53, v52, 4, v53
    v_add_u32 v241, s47, v53
    v_mov_b32 v53, 0x7ffffff0
    v_cmp_le_u32 vcc, 640, v50
    s_nop 1
    v_cndmask_b32 v241, v241, v53, vcc
    v_add_u32 v50, s44, v2
    v_add_u32 v50, 128, v50
    v_mul_hi_u32 v51, v50, s48
    v_mul_u32_u24 v52, 10, v51
    v_sub_u32 v52, v50, v52
    v_mul_lo_u32 v53, v51, s46
    v_lshl_add_u32 v53, v52, 4, v53
    v_add_u32 v242, s47, v53
    v_mov_b32 v53, 0x7ffffff0
    v_cmp_le_u32 vcc, 640, v50
    s_nop 1
    v_cndmask_b32 v242, v242, v53, vcc
    s_waitcnt lgkmcnt(0)
    s_add_u32 s8, s4, 19922944
    s_addc_u32 s9, s5, 0
    s_and_b32 s9, s9, 0xffff
    s_mov_b32 s10, 7077888
    s_mov_b32 s11, 0x00020000
    s_mov_b32 s12, s6
    s_mov_b32 s13, s7
    s_and_b32 s13, s13, 0xffff
    s_mov_b32 s14, 2211840
    s_mov_b32 s15, 0x00020000
    s_mov_b32 s49, 0
    s_mov_b32 s50, 0
    s_mov_b32 s60, 0
    s_mov_b32 s62, 0
    s_mov_b32 s63, 0
    s_lshl_b32 s64, s42, 11
    s_mul_i32 s65, s42, 3072
    s_add_u32 s65, s65, 8192
    s_lshr_b32 s53, s42, 0
    s_and_b32 s54, s42, 0
    v_and_b32 v3, 15, v2
    v_lshrrev_b32 v4, 4, v2
    s_mul_i32 s55, s53, 16
    s_add_u32 s55, s55, s40
    v_add_u32 v5, s55, v3
    s_mul_i32 s56, s54, 80
    s_add_u32 s56, s56, s41
    v_lshl_add_u32 v6, v4, 2, s56
    s_mov_b32 s44, 1280
    v_mul_lo_u32 v7, v5, s44
    v_lshl_add_u32 v7, v6, 1, v7
    v_add_u32 v16, 20480, v7
    s_add_u32 s20, s4, 16777216
    s_addc_u32 s21, s5, 0
    s_and_b32 s21, s21, 0xffff
    s_mov_b32 s22, 2621440
    s_mov_b32 s23, 0x00020000
    s_add_u32 s24, s4, 7340032
    s_addc_u32 s25, s5, 0
    s_and_b32 s25, s25, 0xffff
    s_mov_b32 s26, 2621440
    s_mov_b32 s27, 0x00020000
    buffer_load_dwordx2 v[140:141], v7, s[20:23], 0 offen offset:0
    buffer_load_dwordx2 v[142:143], v7, s[20:23], 0 offen offset:32
    buffer_load_dwordx2 v[144:145], v7, s[20:23], 0 offen offset:64
    buffer_load_dwordx2 v[146:147], v7, s[20:23], 0 offen offset:96
    buffer_load_dwordx2 v[148:149], v7, s[20:23], 0 offen offset:128
    buffer_load_dwordx2 v[150:151], v7, s[24:27], 0 offen offset:0
    buffer_load_dwordx2 v[152:153], v7, s[24:27], 0 offen offset:32
    buffer_load_dwordx2 v[154:155], v7, s[24:27], 0 offen offset:64
    buffer_load_dwordx2 v[156:157], v7, s[24:27], 0 offen offset:96
    buffer_load_dwordx2 v[158:159], v7, s[24:27], 0 offen offset:128
    s_cmp_lt_u32 s60, 27
    s_cselect_b32 s61, s62, 0x7ffffff0
    s_add_u32 s60, s60, 1
    s_add_u32 s62, s62, 128
    s_add_u32 m0, s63, s64
    s_nop 0
    buffer_load_dwordx4 v10, s[8:11], s61 offen lds
    s_add_u32 m0, m0, 1024
    s_nop 0
    buffer_load_dwordx4 v11, s[8:11], s61 offen lds
    s_add_u32 m0, s63, s65
    s_nop 0
    buffer_load_dwordx4 v240, s[12:15], s49 offen lds
    s_add_u32 m0, m0, 1024
    s_nop 0
    buffer_load_dwordx4 v241, s[12:15], s49 offen lds
    s_add_u32 m0, m0, 1024
    s_nop 0
    buffer_load_dwordx4 v242, s[12:15], s49 offen lds
    s_add_u32 s49, s49, 81920
    s_add_u32 s63, s63, 20480
    s_cmp_eq_u32 s63, 122880
    s_cselect_b32 s63, 0, s63
    s_cmp_lt_u32 s60, 27
    s_cselect_b32 s61, s62, 0x7ffffff0
    s_add_u32 s60, s60, 1
    s_add_u32 s62, s62, 128
    s_add_u32 m0, s63, s64
    s_nop 0
    buffer_load_dwordx4 v10, s[8:11], s61 offen lds
    s_add_u32 m0, m0, 1024
    s_nop 0
    buffer_load_dwordx4 v11, s[8:11], s61 offen lds
    s_add_u32 m0, s63, s65
    s_nop 0
    buffer_load_dwordx4 v240, s[12:15], s49 offen lds
    s_add_u32 m0, m0, 1024
    s_nop 0
    buffer_load_dwordx4 v241, s[12:15], s49 offen lds
    s_add_u32 m0, m0, 1024
    s_nop 0
    buffer_load_dwordx4 v242, s[12:15], s49 offen lds
    s_add_u32 s49, s49, 81920
    s_add_u32 s63, s63, 20480
    s_cmp_eq_u32 s63, 122880
    s_cselect_b32 s63, 0, s63
    s_cmp_lt_u32 s60, 27
    s_cselect_b32 s61, s62, 0x7ffffff0
    s_add_u32 s60, s60, 1
    s_add_u32 s62, s62, 128
    s_add_u32 m0, s63, s64
    s_nop 0
    buffer_load_dwordx4 v10, s[8:11], s61 offen lds
    s_add_u32 m0, m0, 1024
    s_nop 0
    buffer_load_dwordx4 v11, s[8:11], s61 offen lds
    s_add_u32 m0, s63, s65
    s_nop 0
    buffer_load_dwordx4 v240, s[12:15], s49 offen lds
    s_add_u32 m0, m0, 1024
    s_nop 0
    buffer_load_dwordx4 v241, s[12:15], s49 offen lds
    s_add_u32 m0, m0, 1024
    s_nop 0
    buffer_load_dwordx4 v242, s[12:15], s49 offen lds
    s_add_u32 s49, s49, 81920
    s_add_u32 s63, s63, 20480
    s_cmp_eq_u32 s63, 122880
    s_cselect_b32 s63, 0, s63
    s_cmp_lt_u32 s60, 27
    s_cselect_b32 s61, s62, 0x7ffffff0
    s_add_u32 s60, s60, 1
    s_add_u32 s62, s62, 128
    s_add_u32 m0, s63, s64
    s_nop 0
    buffer_load_dwordx4 v10, s[8:11], s61 offen lds
    s_add_u32 m0, m0, 1024
    s_nop 0
    buffer_load_dwordx4 v11, s[8:11], s61 offen lds
    s_add_u32 m0, s63, s65
    s_nop 0
    buffer_load_dwordx4 v240, s[12:15], s49 offen lds
    s_add_u32 m0, m0, 1024
    s_nop 0
    buffer_load_dwordx4 v241, s[12:15], s49 offen lds
    s_add_u32 m0, m0, 1024
    s_nop 0
    buffer_load_dwordx4 v242, s[12:15], s49 offen lds
    s_add_u32 s49, s49, 81920
    s_add_u32 s63, s63, 20480
    s_cmp_eq_u32 s63, 122880
    s_cselect_b32 s63, 0, s63
    s_cmp_lt_u32 s60, 27
    s_cselect_b32 s61, s62, 0x7ffffff0
    s_add_u32 s60, s60, 1
    s_add_u32 s62, s62, 128
    s_add_u32 m0, s63, s64
    s_nop 0
    buffer_load_dwordx4 v10, s[8:11], s61 offen lds
    s_add_u32 m0, m0, 1024
    s_nop 0
    buffer_load_dwordx4 v11, s[8:11], s61 offen lds
    s_add_u32 m0, s63, s65
    s_nop 0
    buffer_load_dwordx4 v240, s[12:15], s49 offen lds
    s_add_u32 m0, m0, 1024
    s_nop 0
    buffer_load_dwordx4 v241, s[12:15], s49 offen lds
    s_add_u32 m0, m0, 1024
    s_nop 0
    buffer_load_dwordx4 v242, s[12:15], s49 offen lds
    s_add_u32 s49, s49, 81920
    s_add_u32 s63, s63, 20480
    s_cmp_eq_u32 s63, 122880
    s_cselect_b32 s63, 0, s63
    s_lshr_b32 s53, s42, 0
    s_and_b32 s54, s42, 0
    v_and_b32 v3, 15, v2
    v_lshrrev_b32 v4, 4, v2
    v_and_b32 v22, 7, v3
    v_xor_b32 v22, v22, v4
    v_lshlrev_b32 v22, 4, v22
    v_lshl_add_u32 v22, v3, 7, v22
    s_mul_i32 s55, s53, 2048
    v_add_u32 v22, s55, v22
    v_xor_b32 v23, 64, v22
    v_lshrrev_b32 v24, 2, v3
    v_lshl_add_u32 v24, v4, 3, v24
    v_mul_u32_u24 v24, 160, v24
    v_and_b32 v25, 3, v2
    v_lshl_add_u32 v24, v25, 3, v24
    s_mul_i32 s55, s54, 160
    s_add_u32 s55, s55, 8192
    v_add_u32 v24, s55, v24
    v_mov_b32 v72, 0
    v_mov_b32 v73, 0
    v_mov_b32 v74, 0
    v_mov_b32 v75, 0
    v_mov_b32 v76, 0
    v_mov_b32 v77, 0
    v_mov_b32 v78, 0
    v_mov_b32 v79, 0
    v_mov_b32 v80, 0
    v_mov_b32 v81, 0
    v_mov_b32 v82, 0
    v_mov_b32 v83, 0
    v_mov_b32 v84, 0
    v_mov_b32 v85, 0
    v_mov_b32 v86, 0
    v_mov_b32 v87, 0
    v_mov_b32 v88, 0
    v_mov_b32 v89, 0
    v_mov_b32 v90, 0
    v_mov_b32 v91, 0
    v_mov_b32 v60, 0
    v_mov_b32 v62, 0
    v_mov_b32 v64, 0x3f803f80
    s_mov_b32 s66, 0
    s_mov_b32 s51, 27
k7_w4_kernel_loop:
    s_waitcnt vmcnt(20)
    s_barrier
    v_add_u32 v26, s66, v22
    v_add_u32 v27, s66, v23
    v_add_u32 v28, s66, v24
    ds_read_b128 v[92:95], v26 offset:0
    ds_read_b64_tr_b16 v[96:97], v28 offset:0
    ds_read_b64_tr_b16 v[98:99], v28 offset:640
    ds_read_b64_tr_b16 v[100:101], v28 offset:32
    ds_read_b64_tr_b16 v[102:103], v28 offset:672
    ds_read_b64_tr_b16 v[104:105], v28 offset:64
    ds_read_b64_tr_b16 v[106:107], v28 offset:704
    ds_read_b64_tr_b16 v[108:109], v28 offset:96
    ds_read_b64_tr_b16 v[110:111], v28 offset:736
    ds_read_b64_tr_b16 v[112:113], v28 offset:128
    ds_read_b64_tr_b16 v[114:115], v28 offset:768
    ds_read_b128 v[116:119], v27 offset:0
    ds_read_b64_tr_b16 v[120:121], v28 offset:5120
    ds_read_b64_tr_b16 v[122:123], v28 offset:5760
    ds_read_b64_tr_b16 v[124:125], v28 offset:5152
    ds_read_b64_tr_b16 v[126:127], v28 offset:5792
    ds_read_b64_tr_b16 v[128:129], v28 offset:5184
    ds_read_b64_tr_b16 v[130:131], v28 offset:5824
    ds_read_b64_tr_b16 v[132:133], v28 offset:5216
    ds_read_b64_tr_b16 v[134:135], v28 offset:5856
    ds_read_b64_tr_b16 v[136:137], v28 offset:5248
    ds_read_b64_tr_b16 v[138:139], v28 offset:5888
    s_cmp_lt_u32 s60, 27
    s_cselect_b32 s61, s62, 0x7ffffff0
    s_add_u32 s60, s60, 1
    s_add_u32 s62, s62, 128
    s_add_u32 m0, s63, s64
    s_nop 0
    buffer_load_dwordx4 v10, s[8:11], s61 offen lds
    s_add_u32 m0, m0, 1024
    s_nop 0
    buffer_load_dwordx4 v11, s[8:11], s61 offen lds
    s_add_u32 m0, s63, s65
    s_nop 0
    buffer_load_dwordx4 v240, s[12:15], s49 offen lds
    s_add_u32 m0, m0, 1024
    s_nop 0
    buffer_load_dwordx4 v241, s[12:15], s49 offen lds
    s_add_u32 m0, m0, 1024
    s_nop 0
    buffer_load_dwordx4 v242, s[12:15], s49 offen lds
    s_add_u32 s49, s49, 81920
    s_add_u32 s63, s63, 20480
    s_cmp_eq_u32 s63, 122880
    s_cselect_b32 s63, 0, s63
    s_waitcnt lgkmcnt(11)
    v_mfma_f32_16x16x32_bf16 v[72:75], v[96:99], v[92:95], v[72:75]
    v_mfma_f32_16x16x32_bf16 v[76:79], v[100:103], v[92:95], v[76:79]
    v_mfma_f32_16x16x32_bf16 v[80:83], v[104:107], v[92:95], v[80:83]
    v_mfma_f32_16x16x32_bf16 v[84:87], v[108:111], v[92:95], v[84:87]
    v_mfma_f32_16x16x32_bf16 v[88:91], v[112:115], v[92:95], v[88:91]
    s_waitcnt lgkmcnt(0)
    v_mfma_f32_16x16x32_bf16 v[72:75], v[120:123], v[116:119], v[72:75]
    v_mfma_f32_16x16x32_bf16 v[76:79], v[124:127], v[116:119], v[76:79]
    v_mfma_f32_16x16x32_bf16 v[80:83], v[128:131], v[116:119], v[80:83]
    v_mfma_f32_16x16x32_bf16 v[84:87], v[132:135], v[116:119], v[84:87]
    v_mfma_f32_16x16x32_bf16 v[88:91], v[136:139], v[116:119], v[88:91]
    s_add_u32 s66, s66, 20480
    s_cmp_eq_u32 s66, 122880
    s_cselect_b32 s66, 0, s66
    s_sub_u32 s51, s51, 1
    s_cmp_lg_u32 s51, 0
    s_cbranch_scc1 k7_w4_kernel_loop
    s_waitcnt vmcnt(0)
    s_barrier
    s_nop 7
    s_waitcnt vmcnt(0)
    s_mov_b32 s16, s36
    s_mov_b32 s17, s37
    s_and_b32 s17, s17, 0xffff
    s_mov_b32 s18, 2621440
    s_mov_b32 s19, 0x00020000
    v_lshlrev_b32 v50, 16, v140
    v_and_b32 v51, 0xffff0000, v140
    v_add_f32 v72, v72, v50
    v_add_f32 v73, v73, v51
    v_lshlrev_b32 v50, 16, v141
    v_and_b32 v51, 0xffff0000, v141
    v_add_f32 v74, v74, v50
    v_add_f32 v75, v75, v51
    v_lshlrev_b32 v50, 16, v142
    v_and_b32 v51, 0xffff0000, v142
    v_add_f32 v76, v76, v50
    v_add_f32 v77, v77, v51
    v_lshlrev_b32 v50, 16, v143
    v_and_b32 v51, 0xffff0000, v143
    v_add_f32 v78, v78, v50
    v_add_f32 v79, v79, v51
    v_lshlrev_b32 v50, 16, v144
    v_and_b32 v51, 0xffff0000, v144
    v_add_f32 v80, v80, v50
    v_add_f32 v81, v81, v51
    v_lshlrev_b32 v50, 16, v145
    v_and_b32 v51, 0xffff0000, v145
    v_add_f32 v82, v82, v50
    v_add_f32 v83, v83, v51
    v_lshlrev_b32 v50, 16, v146
    v_and_b32 v51, 0xffff0000, v146
    v_add_f32 v84, v84, v50
    v_add_f32 v85, v85, v51
    v_lshlrev_b32 v50, 16, v147
    v_and_b32 v51, 0xffff0000, v147
    v_add_f32 v86, v86, v50
    v_add_f32 v87, v87, v51
    v_lshlrev_b32 v50, 16, v148
    v_and_b32 v51, 0xffff0000, v148
    v_add_f32 v88, v88, v50
    v_add_f32 v89, v89, v51
    v_lshlrev_b32 v50, 16, v149
    v_and_b32 v51, 0xffff0000, v149
    v_add_f32 v90, v90, v50
    v_add_f32 v91, v91, v51
    v_cvt_pk_bf16_f32 v50, v72, v73
    v_lshlrev_b32 v72, 16, v50
    v_and_b32 v73, 0xffff0000, v50
    v_cvt_pk_bf16_f32 v50, v74, v75
    v_lshlrev_b32 v74, 16, v50
    v_and_b32 v75, 0xffff0000, v50
    v_cvt_pk_bf16_f32 v50, v76, v77
    v_lshlrev_b32 v76, 16, v50
    v_and_b32 v77, 0xffff0000, v50
    v_cvt_pk_bf16_f32 v50, v78, v79
    v_lshlrev_b32 v78, 16, v50
    v_and_b32 v79, 0xffff0000, v50
    v_cvt_pk_bf16_f32 v50, v80, v81
    v_lshlrev_b32 v80, 16, v50
    v_and_b32 v81, 0xffff0000, v50
    v_cvt_pk_bf16_f32 v50, v82, v83
    v_lshlrev_b32 v82, 16, v50
    v_and_b32 v83, 0xffff0000, v50
    v_cvt_pk_bf16_f32 v50, v84, v85
    v_lshlrev_b32 v84, 16, v50
    v_and_b32 v85, 0xffff0000, v50
    v_cvt_pk_bf16_f32 v50, v86, v87
    v_lshlrev_b32 v86, 16, v50
    v_and_b32 v87, 0xffff0000, v50
    v_cvt_pk_bf16_f32 v50, v88, v89
    v_lshlrev_b32 v88, 16, v50
    v_and_b32 v89, 0xffff0000, v50
    v_cvt_pk_bf16_f32 v50, v90, v91
    v_lshlrev_b32 v90, 16, v50
    v_and_b32 v91, 0xffff0000, v50
    v_lshlrev_b32 v50, 16, v150
    v_and_b32 v51, 0xffff0000, v150
    v_add_f32 v72, v72, v50
    v_add_f32 v73, v73, v51
    v_lshlrev_b32 v50, 16, v151
    v_and_b32 v51, 0xffff0000, v151
    v_add_f32 v74, v74, v50
    v_add_f32 v75, v75, v51
    v_lshlrev_b32 v50, 16, v152
    v_and_b32 v51, 0xffff0000, v152
    v_add_f32 v76, v76, v50
    v_add_f32 v77, v77, v51
    v_lshlrev_b32 v50, 16, v153
    v_and_b32 v51, 0xffff0000, v153
    v_add_f32 v78, v78, v50
    v_add_f32 v79, v79, v51
    v_lshlrev_b32 v50, 16, v154
    v_and_b32 v51, 0xffff0000, v154
    v_add_f32 v80, v80, v50
    v_add_f32 v81, v81, v51
    v_lshlrev_b32 v50, 16, v155
    v_and_b32 v51, 0xffff0000, v155
    v_add_f32 v82, v82, v50
    v_add_f32 v83, v83, v51
    v_lshlrev_b32 v50, 16, v156
    v_and_b32 v51, 0xffff0000, v156
    v_add_f32 v84, v84, v50
    v_add_f32 v85, v85, v51
    v_lshlrev_b32 v50, 16, v157
    v_and_b32 v51, 0xffff0000, v157
    v_add_f32 v86, v86, v50
    v_add_f32 v87, v87, v51
    v_lshlrev_b32 v50, 16, v158
    v_and_b32 v51, 0xffff0000, v158
    v_add_f32 v88, v88, v50
    v_add_f32 v89, v89, v51
    v_lshlrev_b32 v50, 16, v159
    v_and_b32 v51, 0xffff0000, v159
    v_add_f32 v90, v90, v50
    v_add_f32 v91, v91, v51
    v_cvt_pk_bf16_f32 v50, v72, v73
    v_cvt_pk_bf16_f32 v51, v74, v75
    buffer_store_dwordx2 v[50:51], v7, s[16:19], 0 offen offset:0
    v_cvt_pk_bf16_f32 v50, v76, v77
    v_cvt_pk_bf16_f32 v51, v78, v79
    buffer_store_dwordx2 v[50:51], v7, s[16:19], 0 offen offset:32
    v_cvt_pk_bf16_f32 v50, v80, v81
    v_cvt_pk_bf16_f32 v51, v82, v83
    buffer_store_dwordx2 v[50:51], v7, s[16:19], 0 offen offset:64
    v_cvt_pk_bf16_f32 v50, v84, v85
    v_cvt_pk_bf16_f32 v51, v86, v87
    buffer_store_dwordx2 v[50:51], v7, s[16:19], 0 offen offset:96
    v_cvt_pk_bf16_f32 v50, v88, v89
    v_cvt_pk_bf16_f32 v51, v90, v91
    buffer_store_dwordx2 v[50:51], v7, s[16:19], 0 offen offset:128
    s_waitcnt vmcnt(0)
    s_branch k7_w4_kernel_end
k7_w4_kernel_end:
    s_endpgm
.section .rodata,"a"
.p2align 6
.amdhsa_kernel k1_qkv_kernel
  .amdhsa_next_free_vgpr 256
  .amdhsa_next_free_sgpr 102
  .amdhsa_accum_offset 256
  .amdhsa_group_segment_fixed_size 0
  .amdhsa_kernarg_size 104
  .amdhsa_user_sgpr_count 2
  .amdhsa_user_sgpr_kernarg_segment_ptr 1
  .amdhsa_system_sgpr_workgroup_id_x 1
.end_amdhsa_kernel
.p2align 6
.amdhsa_kernel k2_attn_kernel
  .amdhsa_next_free_vgpr 128
  .amdhsa_next_free_sgpr 102
  .amdhsa_accum_offset 128
  .amdhsa_group_segment_fixed_size 0
  .amdhsa_kernarg_size 104
  .amdhsa_user_sgpr_count 2
  .amdhsa_user_sgpr_kernarg_segment_ptr 1
  .amdhsa_system_sgpr_workgroup_id_x 1
.end_amdhsa_kernel
.p2align 6
.amdhsa_kernel k3_wo_kernel
  .amdhsa_next_free_vgpr 256
  .amdhsa_next_free_sgpr 102
  .amdhsa_accum_offset 256
  .amdhsa_group_segment_fixed_size 0
  .amdhsa_kernarg_size 104
  .amdhsa_user_sgpr_count 2
  .amdhsa_user_sgpr_kernarg_segment_ptr 1
  .amdhsa_system_sgpr_workgroup_id_x 1
.end_amdhsa_kernel
.p2align 6
.amdhsa_kernel k4_w1_kernel
  .amdhsa_next_free_vgpr 256
  .amdhsa_next_free_sgpr 102
  .amdhsa_accum_offset 256
  .amdhsa_group_segment_fixed_size 0
  .amdhsa_kernarg_size 104
  .amdhsa_user_sgpr_count 2
  .amdhsa_user_sgpr_kernarg_segment_ptr 1
  .amdhsa_system_sgpr_workgroup_id_x 1
.end_amdhsa_kernel
.p2align 6
.amdhsa_kernel k5_w2_kernel
  .amdhsa_next_free_vgpr 256
  .amdhsa_next_free_sgpr 102
  .amdhsa_accum_offset 256
  .amdhsa_group_segment_fixed_size 0
  .amdhsa_kernarg_size 104
  .amdhsa_user_sgpr_count 2
  .amdhsa_user_sgpr_kernarg_segment_ptr 1
  .amdhsa_system_sgpr_workgroup_id_x 1
.end_amdhsa_kernel
.p2align 6
.amdhsa_kernel k6_w3_kernel
  .amdhsa_next_free_vgpr 256
  .amdhsa_next_free_sgpr 102
  .amdhsa_accum_offset 256
  .amdhsa_group_segment_fixed_size 0
  .amdhsa_kernarg_size 104
  .amdhsa_user_sgpr_count 2
  .amdhsa_user_sgpr_kernarg_segment_ptr 1
  .amdhsa_system_sgpr_workgroup_id_x 1
.end_amdhsa_kernel
.p2align 6
.amdhsa_kernel k7_w4_kernel
  .amdhsa_next_free_vgpr 256
  .amdhsa_next_free_sgpr 102
  .amdhsa_accum_offset 256
  .amdhsa_group_segment_fixed_size 0
  .amdhsa_kernarg_size 104
  .amdhsa_user_sgpr_count 2
  .amdhsa_user_sgpr_kernarg_segment_ptr 1
  .amdhsa_system_sgpr_workgroup_id_x 1
.end_amdhsa_kernel
```
